```python
import torch

def _softmax(x, axis=-1):
    return torch.softmax(x, dim=axis)
def _gelu(x):
    return torch.nn.functional.gelu(x, approximate="tanh")
def _silu(x):
    return torch.nn.functional.silu(x)
def _sigmoid(x):
    return torch.sigmoid(x)
def _layernorm(x, axis=-1, eps=1e-5):
    m = x.mean(dim=axis, keepdim=True)
    v = x.var(dim=axis, keepdim=True, unbiased=False)
    return (x - m) / torch.sqrt(v + eps)
def _scatter_add(tgt, idx, src, axis=0):
    return tgt.clone().index_add_(axis, idx, src)
def _segment_sum(src, seg, n):
    out = torch.zeros((n,) + src.shape[1:], dtype=src.dtype)
    return out.index_add_(0, seg, src)
def _pad(x, pw):
    flat = tuple(v for pair in reversed(pw) for v in pair)
    return torch.nn.functional.pad(x, flat)

kernel_name = 'gated_mix__gqa_block_cached__dense_activation_gelu__decode'

def setup_inputs():

    _w = (lambda a: (lambda t: t.to(torch.bfloat16) if t.is_floating_point() else t)(torch.as_tensor(a)))
    def _A_setup():
        B, Sq, D = 4, 1, 512
        Hq, Hkv, Sk, Dh = 32, 8, 8192, 128
        assert Hq % Hkv == 0, (Hq, Hkv)
        return {
            "x": _w((lambda *s: torch.randn(*s, dtype=torch.bfloat16) * 0.05)(B, Sq, D)),
            "k_cache": _w((lambda *s: torch.randn(*s, dtype=torch.bfloat16) * 6.4)(B, Hkv, Sk, Dh)),
            "v_cache": _w((lambda *s: torch.randn(*s, dtype=torch.bfloat16) * 0.1)(B, Hkv, Sk, Dh)),
            "wq": _w((lambda *s: torch.randn(*s, dtype=torch.bfloat16) * 6.4)(D, Hq * Dh) * (D ** -0.5)),
            "wo": _w((lambda *s: torch.randn(*s, dtype=torch.bfloat16) * 0.1)(Hq * Dh, D) * ((Hq * Dh) ** -0.5)),
        }
    _A_in = _A_setup()

    def _B_setup():
        B, S, D, F = 4, 1, 512, 1792
        return {
            "x": _w((lambda *s: torch.randn(*s, dtype=torch.bfloat16) * 0.05)(B, S, D)),
            "w1": _w((lambda *s: torch.randn(*s, dtype=torch.bfloat16) * 3.2)(D, F) * (D ** -0.5)),
            "b1": _w((lambda *s: torch.randn(*s, dtype=torch.bfloat16) * 3.2)(F) * 0.01),
            "w2": _w((lambda *s: torch.randn(*s, dtype=torch.bfloat16) * 0.05)(F, D) * (F ** -0.5)),
            "b2": _w((lambda *s: torch.randn(*s, dtype=torch.bfloat16) * 0.1)(D) * 0.01),
        }
    _B_in = _B_setup()

    return {
        "A_x": _A_in["x"],
        "A_k_cache": _A_in["k_cache"],
        "A_v_cache": _A_in["v_cache"],
        "A_wq": _A_in["wq"],
        "A_wo": _A_in["wo"],
        "B_x": _B_in["x"],
        "B_w1": _B_in["w1"],
        "B_b1": _B_in["b1"],
        "B_w2": _B_in["w2"],
        "B_b2": _B_in["b2"],
        "gate_w": _w((lambda *s: torch.randn(*s, dtype=torch.bfloat16) * 0.05)(512) * 16.0),
    }

def reference(A_x, A_k_cache, A_v_cache, A_wq, A_wo, B_x, B_w1, B_b1, B_w2, B_b2, gate_w):
    def _A_ref(x, k_cache, v_cache, wq, wo):
        B, Sq, D = x.shape
        Hq, Dh = 32, 128
        Hkv = k_cache.shape[1]
        rep = Hq // Hkv
        q = (lambda x, *d: x.permute(*d))((x @ wq).reshape(B, Sq, Hq, Dh), 0, 2, 1, 3)
        k = (lambda x, n, axis: torch.repeat_interleave(x, n, dim=axis))(k_cache, rep, axis=1)
        v = (lambda x, n, axis: torch.repeat_interleave(x, n, dim=axis))(v_cache, rep, axis=1)
        scores = torch.einsum("bhqd,bhkd->bhqk", q, k) * (Dh ** -0.5)
        p = _softmax(scores, axis=-1)
        o = torch.einsum("bhqk,bhkd->bhqd", p, v)
        return (lambda x, *d: x.permute(*d))(o, 0, 2, 1, 3).reshape(B, Sq, Hq * Dh) @ wo

    def _B_ref(x, w1, b1, w2, b2):
        h = torch.einsum("bsd,df->bsf", x, w1) + b1
        h = _gelu(h)
        return torch.einsum("bsf,fd->bsd", h, w2) + b2

    x = A_x
    g = _sigmoid((x * gate_w).sum(-1, keepdims=True))
    a = _A_ref(x, A_k_cache, A_v_cache, A_wq, A_wo)
    b = _B_ref(x, B_w1, B_b1, B_w2, B_b2)
    return g * a + (1 - g) * b
```

```asm
; @launch grid=(256,1,1) block=(512,1,1) lds=79488
.amdgcn_target "amdgcn-amd-amdhsa--gfx950"
.text

.globl gated_mix__gqa_block_cached__dense_activation_gelu__decode_kernel
.p2align 8
.type gated_mix__gqa_block_cached__dense_activation_gelu__decode_kernel,@function
gated_mix__gqa_block_cached__dense_activation_gelu__decode_kernel:
    s_load_dwordx16 s[16:31], s[0:1], 0
    s_load_dwordx8 s[32:39], s[0:1], 64
    s_load_dwordx4 s[40:43], s[0:1], 96
    v_lshrrev_b32 v5, 6, v0
    v_and_b32 v1, 63, v0
    v_readfirstlane_b32 s3, v5
    s_and_b32 s4, s2, 7
    s_lshr_b32 s5, s2, 3
    s_lshr_b32 s6, s2, 6
    s_lshl_b32 s8, s6, 6
    s_lshl3_add_u32 s8, s4, s8
    s_and_b32 s9, s5, 7
    s_add_u32 s8, s8, s9
    s_lshl_b32 s8, s8, 18
    s_lshl_b32 s100, s9, 15
    s_lshl_b32 s9, s3, 12
    s_add_u32 s8, s8, s9
    v_and_b32 v5, 3, v0
    v_lshlrev_b32 v2, 4, v5
    v_lshrrev_b32 v6, 4, v1
    v_lshl_add_u32 v2, v6, 6, v2
    v_and_b32 v7, 12, v0
    v_lshl_add_u32 v2, v7, 6, v2
    s_mov_b32 s47, 0x20000
    s_sub_u32 s46, 0x40000, s9
    s_cmp_ge_u32 s2, 256
    s_cbranch_scc1 L_end
    s_waitcnt lgkmcnt(0)
    s_add_u32 s44, s18, s8
    s_addc_u32 s45, s19, 0
    buffer_load_dwordx4 v[128:131], v2, s[44:47], s100 offen offset:0 nt
    buffer_load_dwordx4 v[132:135], v2, s[44:47], s100 offen offset:1024 nt
    buffer_load_dwordx4 v[136:139], v2, s[44:47], s100 offen offset:2048 nt
    s_mov_b32 s12, s100
    v_lshlrev_b32 v3, 4, v1
    v_lshlrev_b32 v5, 2, v5
    s_mov_b32 s51, 0x20000
    s_mov_b32 s50, s46
    s_mov_b32 s54, 5242880
    s_mov_b32 s55, 0x20000
    s_lshl2_add_u32 s7, s4, s6
    s_mov_b32 s52, s42
    s_mov_b32 s53, s43
    s_add_u32 s48, s20, s8
    s_addc_u32 s49, s21, 0
    s_cmp_gt_u32 s3, 3
    s_cbranch_scc1 L_plain
    s_cmp_eq_u32 s3, 3
    s_cbranch_scc1 L_cpf
    buffer_load_dword v4, off, s[52:55], 0 sc1
    s_cmp_eq_u32 s3, 2
    s_cbranch_scc1 L_gather
    s_cmp_eq_u32 s3, 0
    s_cbranch_scc0 L_taskb
    s_mov_b32 s56, s22
    s_mov_b32 s57, s23
    s_mov_b32 s58, 4194304
    s_lshl_b32 s14, s4, 3
    s_lshr_b32 s10, s5, 2
    s_add_u32 s14, s14, s10
    s_mov_b32 s10, 8192
    s_and_b32 s15, s5, 3
    s_lshl_b32 s26, s15, 14
    s_add_u32 s26, s26, 65536
    s_mov_b32 s27, 16
    s_lshl_b32 s14, s14, 1
    s_mov_b32 s13, s14
    s_mov_b32 s62, -1
    s_mov_b32 s63, -1
    s_branch L_task
L_taskb:
    s_and_b32 s15, s5, 3
    s_lshr_b32 s13, s5, 2
    s_mul_i32 s14, s4, 7
    s_and_b32 s14, s14, -2
    s_add_u32 s14, s14, s13
    s_mov_b32 s56, s28
    s_mov_b32 s57, s29
    s_mov_b32 s58, 1835008
    s_mov_b32 s10, 3584
    s_lshl4_add_u32 s26, s4, s15
    s_lshl_b32 s26, s26, 10
    s_add_u32 s26, s26, 327680
    s_mov_b32 s27, 12
    s_mov_b32 s62, 0x0f0f0f0f
    s_mov_b32 s63, 0x00ff00ff
L_task:
    s_mov_b32 s59, 0x20000
    s_lshl_b32 s12, s15, 7
    s_mul_i32 s12, s12, s10
    s_lshl_b32 s8, s14, 6
    s_add_u32 s12, s12, s8
    v_lshrrev_b32 v7, 3, v1
    v_mul_lo_u32 v7, v7, s10
    v_and_b32 v64, 7, v1
    v_lshl_add_u32 v7, v64, 4, v7
    s_lshl_b32 s10, s10, 3
    s_lshl_b32 s9, s3, 14
    s_add_u32 s9, s9, 46720
    s_mov_b32 m0, s9
    v_and_b32 v64, 0xf0, v3
    s_mov_b32 exec_lo, s62
    s_mov_b32 exec_hi, s62
    buffer_load_dwordx4 v7, s[56:59], s12 offen nt lds
    s_add_u32 m0, m0, 1024
    s_add_u32 s12, s12, s10
    buffer_load_dwordx4 v7, s[56:59], s12 offen nt lds
    s_add_u32 m0, m0, 1024
    s_add_u32 s12, s12, s10
    buffer_load_dwordx4 v7, s[56:59], s12 offen nt lds
    s_add_u32 m0, m0, 1024
    s_add_u32 s12, s12, s10
    buffer_load_dwordx4 v7, s[56:59], s12 offen nt lds
    s_add_u32 m0, m0, 1024
    s_add_u32 s12, s12, s10
    buffer_load_dwordx4 v7, s[56:59], s12 offen nt lds
    s_add_u32 m0, m0, 1024
    s_add_u32 s12, s12, s10
    buffer_load_dwordx4 v7, s[56:59], s12 offen nt lds
    s_add_u32 m0, m0, 1024
    s_add_u32 s12, s12, s10
    buffer_load_dwordx4 v7, s[56:59], s12 offen nt lds
    s_add_u32 m0, m0, 1024
    s_add_u32 s12, s12, s10
    buffer_load_dwordx4 v7, s[56:59], s12 offen nt lds
    s_add_u32 m0, m0, 1024
    s_add_u32 s12, s12, s10
    buffer_load_dwordx4 v7, s[56:59], s12 offen nt lds
    s_add_u32 m0, m0, 1024
    s_add_u32 s12, s12, s10
    buffer_load_dwordx4 v7, s[56:59], s12 offen nt lds
    s_add_u32 m0, m0, 1024
    s_add_u32 s12, s12, s10
    buffer_load_dwordx4 v7, s[56:59], s12 offen nt lds
    s_add_u32 m0, m0, 1024
    s_add_u32 s12, s12, s10
    buffer_load_dwordx4 v7, s[56:59], s12 offen nt lds
    s_add_u32 m0, m0, 1024
    s_add_u32 s12, s12, s10
    buffer_load_dwordx4 v7, s[56:59], s12 offen nt lds
    s_add_u32 m0, m0, 1024
    s_add_u32 s12, s12, s10
    buffer_load_dwordx4 v7, s[56:59], s12 offen nt lds
    s_add_u32 m0, m0, 1024
    s_add_u32 s12, s12, s10
    buffer_load_dwordx4 v7, s[56:59], s12 offen nt lds
    s_add_u32 m0, m0, 1024
    s_add_u32 s12, s12, s10
    buffer_load_dwordx4 v7, s[56:59], s12 offen nt lds
    s_mov_b64 exec, -1
    s_mov_b32 s56, s16
    s_mov_b32 s57, s17
    s_mov_b32 s58, 4096
    v_lshl_add_u32 v64, v6, 10, v64
    s_lshl_b32 s11, s3, 10
    s_add_u32 s11, s11, 44672
    s_mov_b32 m0, s11
    s_lshl_b32 s12, s15, 8
    buffer_load_dwordx4 v64, s[56:59], s12 offen lds
    s_mov_b32 s12, s100
    buffer_load_dwordx4 v[140:143], v2, s[44:47], s12 offen offset:3072 nt
    v_bfe_u32 v12, v1, 2, 2
    v_lshlrev_b32 v7, 7, v12
    v_lshl_add_u32 v7, v6, 10, v7
    v_lshl_add_u32 v7, v5, 1, v7
    v_add_u32 v7, s9, v7
    v_lshlrev_b32 v13, 6, v5
    v_lshl_add_u32 v13, v6, 4, v13
    v_add_u32 v13, s11, v13
    v_lshrrev_b32 v14, 2, v5
    v_lshlrev_b32 v14, s27, v14
    v_lshl_add_u32 v14, v12, 6, v14
    v_lshl_add_u32 v14, v6, 4, v14
    s_lshl_b32 s8, s13, 7
    s_add_u32 s26, s26, s8
    v_and_b32 v15, 1, v12
    v_cmp_ne_u32 s[10:11], 0, v15
    v_cmp_lt_u32 vcc, 1, v12
    s_waitcnt vmcnt(1)
    ds_read_b128 v[96:99], v13 offset:0
    ds_read_b128 v[100:103], v13 offset:64
    ds_read_b128 v[104:107], v13 offset:128
    ds_read_b128 v[108:111], v13 offset:192
    ds_read_b64_tr_b16 v[64:65], v7 offset:0
    ds_read_b64_tr_b16 v[66:67], v7 offset:512
    ds_read_b64_tr_b16 v[68:69], v7 offset:32
    ds_read_b64_tr_b16 v[70:71], v7 offset:544
    ds_read_b64_tr_b16 v[72:73], v7 offset:64
    ds_read_b64_tr_b16 v[74:75], v7 offset:576
    ds_read_b64_tr_b16 v[76:77], v7 offset:96
    ds_read_b64_tr_b16 v[78:79], v7 offset:608
    v_add_u32 v4, 1, v4
    s_movk_i32 s70, 0xfff
    v_and_b32 v4, s70, v4
    s_waitcnt lgkmcnt(0)
    ds_read_b64_tr_b16 v[80:81], v7 offset:4096
    ds_read_b64_tr_b16 v[82:83], v7 offset:4608
    ds_read_b64_tr_b16 v[84:85], v7 offset:4128
    ds_read_b64_tr_b16 v[86:87], v7 offset:4640
    ds_read_b64_tr_b16 v[88:89], v7 offset:4160
    ds_read_b64_tr_b16 v[90:91], v7 offset:4672
    ds_read_b64_tr_b16 v[92:93], v7 offset:4192
    ds_read_b64_tr_b16 v[94:95], v7 offset:4704
    v_mfma_f32_16x16x32_bf16 v[112:115], v[64:67], v[96:99], 0
    v_mfma_f32_16x16x32_bf16 v[116:119], v[68:71], v[96:99], 0
    v_mfma_f32_16x16x32_bf16 v[120:123], v[72:75], v[96:99], 0
    v_mfma_f32_16x16x32_bf16 v[124:127], v[76:79], v[96:99], 0
    s_waitcnt lgkmcnt(0)
    ds_read_b64_tr_b16 v[64:65], v7 offset:8192
    ds_read_b64_tr_b16 v[66:67], v7 offset:8704
    ds_read_b64_tr_b16 v[68:69], v7 offset:8224
    ds_read_b64_tr_b16 v[70:71], v7 offset:8736
    ds_read_b64_tr_b16 v[72:73], v7 offset:8256
    ds_read_b64_tr_b16 v[74:75], v7 offset:8768
    ds_read_b64_tr_b16 v[76:77], v7 offset:8288
    ds_read_b64_tr_b16 v[78:79], v7 offset:8800
    v_mfma_f32_16x16x32_bf16 v[112:115], v[80:83], v[100:103], v[112:115]
    v_mfma_f32_16x16x32_bf16 v[116:119], v[84:87], v[100:103], v[116:119]
    v_mfma_f32_16x16x32_bf16 v[120:123], v[88:91], v[100:103], v[120:123]
    v_mfma_f32_16x16x32_bf16 v[124:127], v[92:95], v[100:103], v[124:127]
    s_waitcnt lgkmcnt(0)
    ds_read_b64_tr_b16 v[80:81], v7 offset:12288
    ds_read_b64_tr_b16 v[82:83], v7 offset:12800
    ds_read_b64_tr_b16 v[84:85], v7 offset:12320
    ds_read_b64_tr_b16 v[86:87], v7 offset:12832
    ds_read_b64_tr_b16 v[88:89], v7 offset:12352
    ds_read_b64_tr_b16 v[90:91], v7 offset:12864
    ds_read_b64_tr_b16 v[92:93], v7 offset:12384
    ds_read_b64_tr_b16 v[94:95], v7 offset:12896
    v_mfma_f32_16x16x32_bf16 v[112:115], v[64:67], v[104:107], v[112:115]
    v_mfma_f32_16x16x32_bf16 v[116:119], v[68:71], v[104:107], v[116:119]
    v_mfma_f32_16x16x32_bf16 v[120:123], v[72:75], v[104:107], v[120:123]
    v_mfma_f32_16x16x32_bf16 v[124:127], v[76:79], v[104:107], v[124:127]
    s_waitcnt lgkmcnt(0)
    v_mfma_f32_16x16x32_bf16 v[112:115], v[80:83], v[108:111], v[112:115]
    v_mfma_f32_16x16x32_bf16 v[116:119], v[84:87], v[108:111], v[116:119]
    v_mfma_f32_16x16x32_bf16 v[120:123], v[88:91], v[108:111], v[120:123]
    v_mfma_f32_16x16x32_bf16 v[124:127], v[92:95], v[108:111], v[124:127]
    s_getreg_b32 s8, hwreg(HW_REG_XCC_ID, 0, 4)
    s_lshl_b32 s8, s8, 12
    v_mov_b32 v72, s8
    v_mov_b32 v73, s8
    v_mov_b32 v74, s8
    v_mov_b32 v75, s8
    s_nop 0
    v_cndmask_b32 v64, v112, v116, s[10:11]
    v_cndmask_b32 v65, v113, v117, s[10:11]
    v_cndmask_b32 v66, v114, v118, s[10:11]
    v_cndmask_b32 v67, v115, v119, s[10:11]
    v_cndmask_b32 v68, v120, v124, s[10:11]
    v_cndmask_b32 v69, v121, v125, s[10:11]
    v_cndmask_b32 v70, v122, v126, s[10:11]
    v_cndmask_b32 v71, v123, v127, s[10:11]
    v_cndmask_b32 v64, v64, v68, vcc
    v_cndmask_b32 v65, v65, v69, vcc
    v_cndmask_b32 v66, v66, v70, vcc
    v_cndmask_b32 v67, v67, v71, vcc
    v_add_u32 v64, 0x800, v64
    v_add_u32 v65, 0x800, v65
    v_add_u32 v66, 0x800, v66
    v_add_u32 v67, 0x800, v67
    v_bfi_b32 v64, s70, v4, v64
    v_bfi_b32 v65, s70, v4, v65
    v_bfi_b32 v66, s70, v4, v66
    v_bfi_b32 v67, s70, v4, v67
    s_mov_b32 exec_lo, s63
    s_mov_b32 exec_hi, s63
    buffer_store_dwordx4 v[64:67], v14, s[52:55], s26 offen
    s_mov_b64 exec, -1
    s_cmp_eq_u32 s3, 0
    s_cbranch_scc0 L_kt
    v_bfi_b32 v72, s70, v4, v72
    v_bfi_b32 v73, s70, v4, v73
    v_bfi_b32 v74, s70, v4, v74
    v_bfi_b32 v75, s70, v4, v75
    s_lshl_b32 s8, s4, 5
    s_add_u32 s8, s8, s5
    s_lshl_b32 s8, s8, 4
    s_add_u32 s8, s8, 4096
    s_mov_b64 exec, 1
    buffer_store_dwordx4 v[72:75], off, s[52:55], s8
    s_mov_b64 exec, -1
    s_branch L_kt
L_gate:
    buffer_load_dword v4, off, s[52:55], 0 sc1
    global_load_dwordx4 v[64:67], v3, s[36:37]
    global_load_dwordx4 v[68:71], v3, s[16:17] offset:0
    global_load_dwordx4 v[72:75], v3, s[16:17] offset:1024
    global_load_dwordx4 v[76:79], v3, s[16:17] offset:2048
    global_load_dwordx4 v[80:83], v3, s[16:17] offset:3072
    buffer_load_dwordx4 v[140:143], v2, s[44:47], s12 offen offset:3072 nt
    v_mov_b32 v24, 0
    v_mov_b32 v25, 0
    v_mov_b32 v26, 0
    v_mov_b32 v27, 0
    s_waitcnt vmcnt(1)
    v_add_u32 v4, 1, v4
    s_movk_i32 s70, 0xfff
    v_and_b32 v4, s70, v4
    v_dot2_f32_bf16 v24, v64, v68, v24
    v_dot2_f32_bf16 v25, v64, v72, v25
    v_dot2_f32_bf16 v26, v64, v76, v26
    v_dot2_f32_bf16 v27, v64, v80, v27
    v_dot2_f32_bf16 v24, v65, v69, v24
    v_dot2_f32_bf16 v25, v65, v73, v25
    v_dot2_f32_bf16 v26, v65, v77, v26
    v_dot2_f32_bf16 v27, v65, v81, v27
    v_dot2_f32_bf16 v24, v66, v70, v24
    v_dot2_f32_bf16 v25, v66, v74, v25
    v_dot2_f32_bf16 v26, v66, v78, v26
    v_dot2_f32_bf16 v27, v66, v82, v27
    v_dot2_f32_bf16 v24, v67, v71, v24
    v_dot2_f32_bf16 v25, v67, v75, v25
    v_dot2_f32_bf16 v26, v67, v79, v26
    v_dot2_f32_bf16 v27, v67, v83, v27
    s_nop 2
    v_permlane32_swap_b32 v24, v26
    v_permlane32_swap_b32 v25, v27
    v_add_f32 v24, v24, v26
    v_add_f32 v25, v25, v27
    s_nop 1
    v_permlane16_swap_b32 v24, v25
    v_add_f32 v24, v24, v25
    s_nop 1
    v_add_f32_dpp v24, v24, v24 row_ror:8 row_mask:0xf bank_mask:0xf
    s_nop 1
    v_add_f32_dpp v24, v24, v24 row_ror:4 row_mask:0xf bank_mask:0xf
    s_nop 1
    v_add_f32_dpp v24, v24, v24 row_ror:2 row_mask:0xf bank_mask:0xf
    s_nop 1
    v_add_f32_dpp v24, v24, v24 row_ror:1 row_mask:0xf bank_mask:0xf
    v_cvt_pk_bf16_f32 v24, v24, v24
    v_and_b32 v24, 0xffff0000, v24
    v_mul_f32 v24, 0xbfb8aa3b, v24
    v_exp_f32 v24, v24
    s_nop 0
    v_add_f32 v24, 1.0, v24
    v_rcp_f32 v24, v24
    s_nop 0
    v_cvt_pk_bf16_f32 v24, v24, v24
    v_and_b32 v24, 0xffff0000, v24
    v_sub_f32 v25, 1.0, v24
    v_cvt_pk_bf16_f32 v25, v25, v25
    v_and_b32 v25, 0xffff0000, v25
    v_mov_b32 v26, 0
    v_mov_b32 v27, 0
    v_bfi_b32 v24, s70, v4, v24
    v_bfi_b32 v25, s70, v4, v25
    v_bfi_b32 v26, s70, v4, v26
    v_bfi_b32 v27, s70, v4, v27
    v_lshlrev_b32 v7, 4, v6
    s_mov_b32 exec_lo, 0x00010001
    s_mov_b32 exec_hi, 0x00010001
    s_lshl_b32 s8, s4, 6
    buffer_store_dwordx4 v[24:27], v7, s[52:55], s8 offen offset:2048
    s_mov_b64 exec, -1
    s_branch L_kt
L_gather:
    buffer_load_dwordx4 v[140:143], v2, s[44:47], s12 offen offset:3072 nt
    v_and_b32 v50, 15, v1
    v_lshlrev_b32 v51, 12, v6
    v_lshl_add_u32 v51, v50, 4, v51
    s_mul_i32 s8, s6, 224
    s_and_b32 s9, s4, 1
    s_lshl_b32 s9, s9, 7
    s_add_u32 s8, s8, s9
    s_lshl_b32 s9, s4, 14
    s_add_u32 s8, s8, s9
    s_add_u32 s8, s8, 327680
    v_add_u32 v51, s8, v51
    v_cmp_lt_u32 s[60:61], 13, v50
    s_lshl_b32 s9, s4, 6
    s_add_u32 s9, s9, 2048
    v_lshl_add_u32 v55, v6, 4, s9
    v_add_u32 v52, 1024, v51
    v_add_u32 v53, 2048, v51
    v_add_u32 v54, 3072, v51
    v_cndmask_b32 v51, v51, v55, s[60:61]
    v_cndmask_b32 v52, v52, v55, s[60:61]
    v_cndmask_b32 v53, v53, v55, s[60:61]
    v_cndmask_b32 v54, v54, v55, s[60:61]
    v_and_b32 v55, 0x1f0, v3
    s_lshl_b32 s62, s4, 9
    s_add_u32 s62, s62, 4096
    s_mov_b32 s56, s30
    s_mov_b32 s57, s31
    s_mov_b32 s58, 3584
    s_mov_b32 s59, 0x20000
    v_lshlrev_b32 v56, 3, v50
    s_mul_i32 s8, s7, 112
    buffer_load_dwordx2 v[48:49], v56, s[56:59], s8 offen
    s_waitcnt vmcnt(3)
    s_add_u32 s12, s100, 32768
    s_and_b32 s12, s12, 229376
    buffer_load_dwordx4 v[144:147], v2, s[44:47], s12 offen offset:0 nt
    s_waitcnt vmcnt(3)
    buffer_load_dwordx4 v[148:151], v2, s[44:47], s12 offen offset:1024 nt
    s_waitcnt vmcnt(3)
    buffer_load_dwordx4 v[152:155], v2, s[44:47], s12 offen offset:2048 nt
    s_waitcnt vmcnt(3)
    buffer_load_dwordx4 v[156:159], v2, s[44:47], s12 offen offset:3072 nt
    s_waitcnt vmcnt(3)
    s_add_u32 s12, s100, 65536
    s_and_b32 s12, s12, 229376
    buffer_load_dwordx4 v[160:163], v2, s[44:47], s12 offen offset:0 nt
    s_waitcnt vmcnt(3)
    buffer_load_dwordx4 v[164:167], v2, s[44:47], s12 offen offset:1024 nt
    s_waitcnt vmcnt(3)
    buffer_load_dwordx4 v[168:171], v2, s[44:47], s12 offen offset:2048 nt
    s_waitcnt vmcnt(3)
    buffer_load_dwordx4 v[172:175], v2, s[44:47], s12 offen offset:3072 nt
    s_waitcnt vmcnt(3)
    s_add_u32 s12, s100, 98304
    s_and_b32 s12, s12, 229376
    buffer_load_dwordx4 v[176:179], v2, s[44:47], s12 offen offset:0 nt
    s_waitcnt vmcnt(3)
    buffer_load_dwordx4 v[180:183], v2, s[44:47], s12 offen offset:1024 nt
    s_waitcnt vmcnt(3)
    buffer_load_dwordx4 v[184:187], v2, s[44:47], s12 offen offset:2048 nt
    s_waitcnt vmcnt(3)
    buffer_load_dwordx4 v[188:191], v2, s[44:47], s12 offen offset:3072 nt
    s_waitcnt vmcnt(3)
    s_add_u32 s12, s100, 131072
    s_and_b32 s12, s12, 229376
    buffer_load_dwordx4 v[192:195], v2, s[44:47], s12 offen offset:0 nt
    s_waitcnt vmcnt(3)
    buffer_load_dwordx4 v[196:199], v2, s[44:47], s12 offen offset:1024 nt
    s_waitcnt vmcnt(3)
    buffer_load_dwordx4 v[200:203], v2, s[44:47], s12 offen offset:2048 nt
    s_waitcnt vmcnt(3)
    buffer_load_dwordx4 v[204:207], v2, s[44:47], s12 offen offset:3072 nt
    s_waitcnt vmcnt(3)
    s_add_u32 s12, s100, 163840
    s_and_b32 s12, s12, 229376
    buffer_load_dwordx4 v[208:211], v2, s[44:47], s12 offen offset:0 nt
    s_waitcnt vmcnt(3)
    buffer_load_dwordx4 v[212:215], v2, s[44:47], s12 offen offset:1024 nt
    s_waitcnt vmcnt(3)
    buffer_load_dwordx4 v[216:219], v2, s[44:47], s12 offen offset:2048 nt
    s_waitcnt vmcnt(3)
    buffer_load_dwordx4 v[220:223], v2, s[44:47], s12 offen offset:3072 nt
    s_lshl_b32 s8, s6, 16
    s_lshl_b32 s9, s4, 11
    s_add_u32 s8, s8, s9
    s_add_u32 s14, s8, 65536
    s_add_u32 s15, s14, 16384
    s_add_u32 s26, s14, 32768
    s_add_u32 s27, s14, 49152
    buffer_load_dwordx4 v[64:67], v3, s[52:55], s14 offen offset:0 sc1
    buffer_load_dwordx4 v[68:71], v3, s[52:55], s14 offen offset:1024 sc1
    buffer_load_dwordx4 v[72:75], v3, s[52:55], s15 offen offset:0 sc1
    buffer_load_dwordx4 v[76:79], v3, s[52:55], s15 offen offset:1024 sc1
    buffer_load_dwordx4 v[80:83], v3, s[52:55], s26 offen offset:0 sc1
    buffer_load_dwordx4 v[84:87], v3, s[52:55], s26 offen offset:1024 sc1
    buffer_load_dwordx4 v[88:91], v3, s[52:55], s27 offen offset:0 sc1
    buffer_load_dwordx4 v[92:95], v3, s[52:55], s27 offen offset:1024 sc1
    buffer_load_dwordx4 v[28:31], v51, s[52:55], 0 offen sc1
    buffer_load_dwordx4 v[32:35], v52, s[52:55], 0 offen sc1
    buffer_load_dwordx4 v[36:39], v53, s[52:55], 0 offen sc1
    buffer_load_dwordx4 v[40:43], v54, s[52:55], 0 offen sc1
    buffer_load_dwordx4 v[44:47], v55, s[52:55], s62 offen sc1
    s_waitcnt vmcnt(16)
    s_add_u32 s12, s100, 196608
    s_and_b32 s12, s12, 229376
    buffer_load_dwordx4 v[224:227], v2, s[44:47], s12 offen offset:0 nt
    s_waitcnt vmcnt(16)
    buffer_load_dwordx4 v[228:231], v2, s[44:47], s12 offen offset:1024 nt
    s_waitcnt vmcnt(16)
    buffer_load_dwordx4 v[232:235], v2, s[44:47], s12 offen offset:2048 nt
    s_waitcnt vmcnt(16)
    buffer_load_dwordx4 v[236:239], v2, s[44:47], s12 offen offset:3072 nt
    v_mov_b32 v57, 0xff800000
    ds_write_b32 v5, v57 offset:1568
    s_mov_b32 s13, 262144
    s_waitcnt vmcnt(3)
    s_add_u32 s12, s100, 229376
    s_and_b32 s12, s12, 229376
    buffer_load_dwordx4 v[240:243], v2, s[44:47], s12 offen offset:0 nt
    v_add_u32 v4, 1, v4
    s_movk_i32 s70, 0xfff
    v_mov_b32 v58, v4
    v_and_b32 v4, s70, v4
    s_branch L_qchk
L_qpoll:
    s_cmp_gt_u32 s13, 262138
    s_cbranch_scc1 L_nofl
    buffer_wbl2 sc1
    s_waitcnt vmcnt(0)
    buffer_inv sc1
    s_waitcnt vmcnt(0)
L_nofl:
    buffer_load_dwordx4 v[64:67], v3, s[52:55], s14 offen offset:0 sc1
    buffer_load_dwordx4 v[68:71], v3, s[52:55], s14 offen offset:1024 sc1
    buffer_load_dwordx4 v[72:75], v3, s[52:55], s15 offen offset:0 sc1
    buffer_load_dwordx4 v[76:79], v3, s[52:55], s15 offen offset:1024 sc1
    buffer_load_dwordx4 v[80:83], v3, s[52:55], s26 offen offset:0 sc1
    buffer_load_dwordx4 v[84:87], v3, s[52:55], s26 offen offset:1024 sc1
    buffer_load_dwordx4 v[88:91], v3, s[52:55], s27 offen offset:0 sc1
    buffer_load_dwordx4 v[92:95], v3, s[52:55], s27 offen offset:1024 sc1
    buffer_load_dwordx4 v[28:31], v51, s[52:55], 0 offen sc1
    buffer_load_dwordx4 v[32:35], v52, s[52:55], 0 offen sc1
    buffer_load_dwordx4 v[36:39], v53, s[52:55], 0 offen sc1
    buffer_load_dwordx4 v[40:43], v54, s[52:55], 0 offen sc1
    buffer_load_dwordx4 v[44:47], v55, s[52:55], s62 offen sc1
    s_sub_u32 s13, s13, 1
    s_waitcnt vmcnt(0)
    s_cbranch_scc1 L_qdone
L_qchk:
    v_xor_b32 v64, v64, v4
    v_xor_b32 v65, v65, v4
    v_xor_b32 v66, v66, v4
    v_xor_b32 v67, v67, v4
    v_xor_b32 v68, v68, v4
    v_xor_b32 v69, v69, v4
    v_xor_b32 v70, v70, v4
    v_xor_b32 v71, v71, v4
    v_xor_b32 v72, v72, v4
    v_xor_b32 v73, v73, v4
    v_xor_b32 v74, v74, v4
    v_xor_b32 v75, v75, v4
    v_xor_b32 v76, v76, v4
    v_xor_b32 v77, v77, v4
    v_xor_b32 v78, v78, v4
    v_xor_b32 v79, v79, v4
    v_xor_b32 v80, v80, v4
    v_xor_b32 v81, v81, v4
    v_xor_b32 v82, v82, v4
    v_xor_b32 v83, v83, v4
    v_xor_b32 v84, v84, v4
    v_xor_b32 v85, v85, v4
    v_xor_b32 v86, v86, v4
    v_xor_b32 v87, v87, v4
    v_xor_b32 v88, v88, v4
    v_xor_b32 v89, v89, v4
    v_xor_b32 v90, v90, v4
    v_xor_b32 v91, v91, v4
    v_xor_b32 v92, v92, v4
    v_xor_b32 v93, v93, v4
    v_xor_b32 v94, v94, v4
    v_xor_b32 v95, v95, v4
    v_xor_b32 v28, v28, v4
    v_xor_b32 v29, v29, v4
    v_xor_b32 v30, v30, v4
    v_xor_b32 v31, v31, v4
    v_xor_b32 v32, v32, v4
    v_xor_b32 v33, v33, v4
    v_xor_b32 v34, v34, v4
    v_xor_b32 v35, v35, v4
    v_xor_b32 v36, v36, v4
    v_xor_b32 v37, v37, v4
    v_xor_b32 v38, v38, v4
    v_xor_b32 v39, v39, v4
    v_xor_b32 v40, v40, v4
    v_xor_b32 v41, v41, v4
    v_xor_b32 v42, v42, v4
    v_xor_b32 v43, v43, v4
    v_xor_b32 v44, v44, v4
    v_xor_b32 v45, v45, v4
    v_xor_b32 v46, v46, v4
    v_xor_b32 v47, v47, v4
    v_or3_b32 v57, v64, v65, v66
    v_or3_b32 v57, v67, v68, v57
    v_or3_b32 v57, v69, v70, v57
    v_or3_b32 v57, v71, v72, v57
    v_or3_b32 v57, v73, v74, v57
    v_or3_b32 v57, v75, v76, v57
    v_or3_b32 v57, v77, v78, v57
    v_or3_b32 v57, v79, v80, v57
    v_or3_b32 v57, v81, v82, v57
    v_or3_b32 v57, v83, v84, v57
    v_or3_b32 v57, v85, v86, v57
    v_or3_b32 v57, v87, v88, v57
    v_or3_b32 v57, v89, v90, v57
    v_or3_b32 v57, v91, v92, v57
    v_or3_b32 v57, v93, v94, v57
    v_or3_b32 v57, v95, v28, v57
    v_or3_b32 v57, v29, v30, v57
    v_or3_b32 v57, v31, v32, v57
    v_or3_b32 v57, v33, v34, v57
    v_or3_b32 v57, v35, v36, v57
    v_or3_b32 v57, v37, v38, v57
    v_or3_b32 v57, v39, v40, v57
    v_or3_b32 v57, v41, v42, v57
    v_or3_b32 v57, v43, v44, v57
    v_or3_b32 v57, v45, v46, v57
    v_or_b32 v57, v47, v57
    v_and_b32 v57, s70, v57
    v_cmpx_ne_u32 vcc, 0, v57
    s_cbranch_execnz L_qpoll
L_qdone:
    s_mov_b64 exec, -1
    v_add_f32 v64, v64, v72
    v_add_f32 v65, v65, v73
    v_add_f32 v66, v66, v74
    v_add_f32 v67, v67, v75
    v_add_f32 v68, v68, v76
    v_add_f32 v69, v69, v77
    v_add_f32 v70, v70, v78
    v_add_f32 v71, v71, v79
    v_add_f32 v80, v80, v88
    v_add_f32 v81, v81, v89
    v_add_f32 v82, v82, v90
    v_add_f32 v83, v83, v91
    v_add_f32 v84, v84, v92
    v_add_f32 v85, v85, v93
    v_add_f32 v86, v86, v94
    v_add_f32 v87, v87, v95
    v_add_f32 v28, v28, v32
    v_add_f32 v29, v29, v33
    v_add_f32 v30, v30, v34
    v_add_f32 v31, v31, v35
    v_add_f32 v36, v36, v40
    v_add_f32 v37, v37, v41
    v_add_f32 v38, v38, v42
    v_add_f32 v39, v39, v43
    v_add_f32 v64, v64, v80
    v_add_f32 v65, v65, v81
    v_add_f32 v66, v66, v82
    v_add_f32 v67, v67, v83
    v_add_f32 v68, v68, v84
    v_add_f32 v69, v69, v85
    v_add_f32 v70, v70, v86
    v_add_f32 v71, v71, v87
    v_add_f32 v28, v28, v36
    v_add_f32 v29, v29, v37
    v_add_f32 v30, v30, v38
    v_add_f32 v31, v31, v39
    v_cvt_pk_bf16_f32 v72, v64, v65
    v_cvt_pk_bf16_f32 v73, v66, v67
    v_cvt_pk_bf16_f32 v74, v68, v69
    v_cvt_pk_bf16_f32 v75, v70, v71
    v_lshlrev_b32 v56, 3, v1
    ds_write_b64 v56, v[72:73] offset:0
    ds_write_b64 v56, v[74:75] offset:512
    s_getreg_b32 s9, hwreg(HW_REG_XCC_ID, 0, 4)
    v_lshrrev_b32 v44, 12, v44
    v_cmp_eq_u32 vcc, s9, v44
    v_mul_f32 v64, 0x3e800000, v28
    v_mul_f32 v65, 0x3e800000, v29
    v_and_b32 v64, 0xffff0000, v64
    v_and_b32 v65, 0xffff0000, v65
    s_cmp_eq_u64 vcc, -1
    s_cselect_b32 s8, 1, 0
    v_mov_b32 v45, s8
    v_mov_b32 v44, v4
    v_mov_b32 v46, v58
    v_mov_b32 v47, 0
    ds_write_b96 v47, v[44:46] offset:1584
    v_lshlrev_b32 v51, 3, v6
    s_mov_b64 exec, s[60:61]
    ds_write_b64 v51, v[64:65] offset:1536
    s_mov_b64 exec, -1
    v_cvt_pk_bf16_f32 v76, v28, v29
    v_cvt_pk_bf16_f32 v77, v30, v31
    v_lshlrev_b32 v64, 16, v76
    v_and_b32 v65, 0xffff0000, v76
    v_lshlrev_b32 v68, 16, v48
    v_and_b32 v69, 0xffff0000, v48
    v_lshlrev_b32 v66, 16, v77
    v_and_b32 v67, 0xffff0000, v77
    v_lshlrev_b32 v70, 16, v49
    v_and_b32 v71, 0xffff0000, v49
    v_add_f32 v64, v64, v68
    v_add_f32 v65, v65, v69
    v_add_f32 v66, v66, v70
    v_add_f32 v67, v67, v71
    v_cvt_pk_bf16_f32 v76, v64, v65
    v_cvt_pk_bf16_f32 v77, v66, v67
    v_lshlrev_b32 v64, 16, v76
    v_and_b32 v65, 0xffff0000, v76
    v_lshlrev_b32 v66, 16, v77
    v_and_b32 v67, 0xffff0000, v77
    s_mov_b32 s8, 0xbdd2d3e8
    v_mov_b32 v72, 0xc0135761
    v_mul_f32 v68, v64, v64
    v_mul_f32 v69, v65, v65
    v_mul_f32 v70, v66, v66
    v_mul_f32 v71, v67, v67
    v_fma_f32 v68, v68, s8, v72
    v_fma_f32 v69, v69, s8, v72
    v_fma_f32 v70, v70, s8, v72
    v_fma_f32 v71, v71, s8, v72
    v_mul_f32 v68, v68, v64
    v_mul_f32 v69, v69, v65
    v_mul_f32 v70, v70, v66
    v_mul_f32 v71, v71, v67
    v_exp_f32 v68, v68
    v_exp_f32 v69, v69
    v_exp_f32 v70, v70
    v_exp_f32 v71, v71
    s_nop 0
    v_add_f32 v68, 1.0, v68
    v_add_f32 v69, 1.0, v69
    v_add_f32 v70, 1.0, v70
    v_add_f32 v71, 1.0, v71
    v_rcp_f32 v68, v68
    v_rcp_f32 v69, v69
    v_rcp_f32 v70, v70
    v_rcp_f32 v71, v71
    s_nop 0
    v_mul_f32 v68, v68, v64
    v_mul_f32 v69, v69, v65
    v_mul_f32 v70, v70, v66
    v_mul_f32 v71, v71, v67
    v_cvt_pk_bf16_f32 v76, v68, v69
    v_cvt_pk_bf16_f32 v77, v70, v71
    v_cndmask_b32 v76, v76, 0, s[60:61]
    v_cndmask_b32 v77, v77, 0, s[60:61]
    ds_write_b64 v56, v[76:77] offset:1024
    s_waitcnt vmcnt(3)
    buffer_load_dwordx4 v[244:247], v2, s[44:47], s12 offen offset:1024 nt
    s_branch L_issued
L_kt:
    s_add_u32 s12, s100, 32768
    s_and_b32 s12, s12, 229376
    buffer_load_dwordx4 v[144:147], v2, s[44:47], s12 offen offset:0 nt
    s_waitcnt vmcnt(4)
    buffer_load_dwordx4 v[148:151], v2, s[44:47], s12 offen offset:1024 nt
    s_waitcnt vmcnt(4)
    buffer_load_dwordx4 v[152:155], v2, s[44:47], s12 offen offset:2048 nt
    s_waitcnt vmcnt(4)
    buffer_load_dwordx4 v[156:159], v2, s[44:47], s12 offen offset:3072 nt
    s_waitcnt vmcnt(4)
    s_add_u32 s12, s100, 65536
    s_and_b32 s12, s12, 229376
    buffer_load_dwordx4 v[160:163], v2, s[44:47], s12 offen offset:0 nt
    s_waitcnt vmcnt(4)
    buffer_load_dwordx4 v[164:167], v2, s[44:47], s12 offen offset:1024 nt
    s_waitcnt vmcnt(4)
    buffer_load_dwordx4 v[168:171], v2, s[44:47], s12 offen offset:2048 nt
    s_waitcnt vmcnt(4)
    buffer_load_dwordx4 v[172:175], v2, s[44:47], s12 offen offset:3072 nt
    s_waitcnt vmcnt(4)
    s_add_u32 s12, s100, 98304
    s_and_b32 s12, s12, 229376
    buffer_load_dwordx4 v[176:179], v2, s[44:47], s12 offen offset:0 nt
    s_waitcnt vmcnt(4)
    buffer_load_dwordx4 v[180:183], v2, s[44:47], s12 offen offset:1024 nt
    s_waitcnt vmcnt(4)
    buffer_load_dwordx4 v[184:187], v2, s[44:47], s12 offen offset:2048 nt
    s_waitcnt vmcnt(4)
    buffer_load_dwordx4 v[188:191], v2, s[44:47], s12 offen offset:3072 nt
    s_waitcnt vmcnt(4)
    s_add_u32 s12, s100, 131072
    s_and_b32 s12, s12, 229376
    buffer_load_dwordx4 v[192:195], v2, s[44:47], s12 offen offset:0 nt
    s_waitcnt vmcnt(4)
    buffer_load_dwordx4 v[196:199], v2, s[44:47], s12 offen offset:1024 nt
    s_waitcnt vmcnt(4)
    buffer_load_dwordx4 v[200:203], v2, s[44:47], s12 offen offset:2048 nt
    s_waitcnt vmcnt(4)
    buffer_load_dwordx4 v[204:207], v2, s[44:47], s12 offen offset:3072 nt
    s_waitcnt vmcnt(4)
    s_add_u32 s12, s100, 163840
    s_and_b32 s12, s12, 229376
    buffer_load_dwordx4 v[208:211], v2, s[44:47], s12 offen offset:0 nt
    s_waitcnt vmcnt(4)
    buffer_load_dwordx4 v[212:215], v2, s[44:47], s12 offen offset:1024 nt
    s_waitcnt vmcnt(4)
    buffer_load_dwordx4 v[216:219], v2, s[44:47], s12 offen offset:2048 nt
    s_waitcnt vmcnt(4)
    buffer_load_dwordx4 v[220:223], v2, s[44:47], s12 offen offset:3072 nt
    s_waitcnt vmcnt(4)
    s_add_u32 s12, s100, 196608
    s_and_b32 s12, s12, 229376
    buffer_load_dwordx4 v[224:227], v2, s[44:47], s12 offen offset:0 nt
    s_waitcnt vmcnt(4)
    buffer_load_dwordx4 v[228:231], v2, s[44:47], s12 offen offset:1024 nt
    s_waitcnt vmcnt(4)
    buffer_load_dwordx4 v[232:235], v2, s[44:47], s12 offen offset:2048 nt
    s_waitcnt vmcnt(4)
    buffer_load_dwordx4 v[236:239], v2, s[44:47], s12 offen offset:3072 nt
    s_waitcnt vmcnt(4)
    s_add_u32 s12, s100, 229376
    s_and_b32 s12, s12, 229376
    buffer_load_dwordx4 v[240:243], v2, s[44:47], s12 offen offset:0 nt
    s_waitcnt vmcnt(4)
    buffer_load_dwordx4 v[244:247], v2, s[44:47], s12 offen offset:1024 nt
    s_branch L_issued
L_cpf:
    s_cmp_eq_u32 s5, 31
    s_cbranch_scc1 L_gate
    s_sub_u32 s10, 30, s5
    s_cmp_lt_u32 s10, (L_end - L_gather + 1023) >> 10
    s_cbranch_scc0 L_plain
    s_getpc_b64 s[8:9]
L_pc:
    s_lshl_b32 s10, s10, 10
    s_sub_u32 s10, s10, L_pc - L_gather
    s_ashr_i32 s11, s10, 31
    s_add_u32 s8, s8, s10
    s_addc_u32 s9, s9, s11
    global_load_dwordx4 v[64:67], v3, s[8:9]
L_plain:
    s_waitcnt vmcnt(2)
    buffer_load_dwordx4 v[140:143], v2, s[44:47], s12 offen offset:3072 nt
    s_waitcnt vmcnt(2)
    s_add_u32 s12, s100, 32768
    s_and_b32 s12, s12, 229376
    buffer_load_dwordx4 v[144:147], v2, s[44:47], s12 offen offset:0 nt
    s_waitcnt vmcnt(2)
    buffer_load_dwordx4 v[148:151], v2, s[44:47], s12 offen offset:1024 nt
    s_waitcnt vmcnt(2)
    buffer_load_dwordx4 v[152:155], v2, s[44:47], s12 offen offset:2048 nt
    s_waitcnt vmcnt(2)
    buffer_load_dwordx4 v[156:159], v2, s[44:47], s12 offen offset:3072 nt
    s_waitcnt vmcnt(2)
    s_add_u32 s12, s100, 65536
    s_and_b32 s12, s12, 229376
    buffer_load_dwordx4 v[160:163], v2, s[44:47], s12 offen offset:0 nt
    s_waitcnt vmcnt(2)
    buffer_load_dwordx4 v[164:167], v2, s[44:47], s12 offen offset:1024 nt
    s_waitcnt vmcnt(2)
    buffer_load_dwordx4 v[168:171], v2, s[44:47], s12 offen offset:2048 nt
    s_waitcnt vmcnt(2)
    buffer_load_dwordx4 v[172:175], v2, s[44:47], s12 offen offset:3072 nt
    s_waitcnt vmcnt(2)
    s_add_u32 s12, s100, 98304
    s_and_b32 s12, s12, 229376
    buffer_load_dwordx4 v[176:179], v2, s[44:47], s12 offen offset:0 nt
    s_waitcnt vmcnt(2)
    buffer_load_dwordx4 v[180:183], v2, s[44:47], s12 offen offset:1024 nt
    s_waitcnt vmcnt(2)
    buffer_load_dwordx4 v[184:187], v2, s[44:47], s12 offen offset:2048 nt
    s_waitcnt vmcnt(2)
    buffer_load_dwordx4 v[188:191], v2, s[44:47], s12 offen offset:3072 nt
    s_waitcnt vmcnt(2)
    s_add_u32 s12, s100, 131072
    s_and_b32 s12, s12, 229376
    buffer_load_dwordx4 v[192:195], v2, s[44:47], s12 offen offset:0 nt
    s_waitcnt vmcnt(2)
    buffer_load_dwordx4 v[196:199], v2, s[44:47], s12 offen offset:1024 nt
    s_waitcnt vmcnt(2)
    buffer_load_dwordx4 v[200:203], v2, s[44:47], s12 offen offset:2048 nt
    s_waitcnt vmcnt(2)
    buffer_load_dwordx4 v[204:207], v2, s[44:47], s12 offen offset:3072 nt
    s_waitcnt vmcnt(2)
    s_add_u32 s12, s100, 163840
    s_and_b32 s12, s12, 229376
    buffer_load_dwordx4 v[208:211], v2, s[44:47], s12 offen offset:0 nt
    s_waitcnt vmcnt(2)
    buffer_load_dwordx4 v[212:215], v2, s[44:47], s12 offen offset:1024 nt
    s_waitcnt vmcnt(2)
    buffer_load_dwordx4 v[216:219], v2, s[44:47], s12 offen offset:2048 nt
    s_waitcnt vmcnt(2)
    buffer_load_dwordx4 v[220:223], v2, s[44:47], s12 offen offset:3072 nt
    s_waitcnt vmcnt(2)
    s_add_u32 s12, s100, 196608
    s_and_b32 s12, s12, 229376
    buffer_load_dwordx4 v[224:227], v2, s[44:47], s12 offen offset:0 nt
    s_waitcnt vmcnt(2)
    buffer_load_dwordx4 v[228:231], v2, s[44:47], s12 offen offset:1024 nt
    s_waitcnt vmcnt(2)
    buffer_load_dwordx4 v[232:235], v2, s[44:47], s12 offen offset:2048 nt
    s_waitcnt vmcnt(2)
    buffer_load_dwordx4 v[236:239], v2, s[44:47], s12 offen offset:3072 nt
    s_waitcnt vmcnt(2)
    s_add_u32 s12, s100, 229376
    s_and_b32 s12, s12, 229376
    buffer_load_dwordx4 v[240:243], v2, s[44:47], s12 offen offset:0 nt
    s_waitcnt vmcnt(2)
    buffer_load_dwordx4 v[244:247], v2, s[44:47], s12 offen offset:1024 nt
L_issued:
    v_lshlrev_b32 v6, 6, v5
    v_and_b32 v7, 60, v1
    v_lshl_add_u32 v6, v7, 2, v6
    v_mov_b32 v8, 0x3f803f80
    v_mov_b32 v9, 0x3f803f80
    v_mov_b32 v10, 0x3f803f80
    v_mov_b32 v11, 0x3f803f80
    s_mov_b32 s66, 0x05040100
    s_mov_b32 s67, 0x07060302
    s_mov_b32 s68, 0x3e0293ee
    s_mov_b32 s64, 0x000f000f
    s_mov_b32 s65, 0x000f000f
    s_movk_i32 s70, 0xfff
    v_mov_b32 v7, 0
    s_waitcnt lgkmcnt(0)
    s_barrier
    ds_read_b128 v[60:63], v6 offset:0
    ds_read_b96 v[12:14], v7 offset:1584
    s_waitcnt vmcnt(2)
    buffer_load_dwordx4 v[248:251], v2, s[44:47], s12 offen offset:2048 nt
    s_waitcnt lgkmcnt(0)
    v_mfma_f32_16x16x32_bf16 v[64:67], v[128:131], v[60:63], 0
    v_mfma_f32_16x16x32_bf16 v[68:71], v[132:135], v[60:63], 0
    v_mfma_f32_16x16x32_bf16 v[72:75], v[136:139], v[60:63], 0
    v_mfma_f32_16x16x32_bf16 v[76:79], v[140:143], v[60:63], 0
    v_mfma_f32_16x16x32_bf16 v[80:83], v[144:147], v[60:63], 0
    v_mfma_f32_16x16x32_bf16 v[84:87], v[148:151], v[60:63], 0
    v_mfma_f32_16x16x32_bf16 v[88:91], v[152:155], v[60:63], 0
    v_mfma_f32_16x16x32_bf16 v[92:95], v[156:159], v[60:63], 0
    v_mov_b32 v4, v12
    v_readfirstlane_b32 s101, v13
    v_readfirstlane_b32 s62, v14
    s_cmp_eq_u32 s101, 1
    s_cbranch_scc1 L_nowb
    s_cmp_eq_u32 s3, 0
    s_cbranch_scc0 L_nowb
    buffer_wbl2 sc1
    s_waitcnt vmcnt(0)
L_nowb:
    s_nop 0
    v_add_f32_dpp v28, v65, v64 row_shl:4 row_mask:0xf bank_mask:0xf bound_ctrl:0
    v_add_f32_dpp v29, v69, v68 row_shl:4 row_mask:0xf bank_mask:0xf bound_ctrl:0
    v_add_f32_dpp v30, v73, v72 row_shl:4 row_mask:0xf bank_mask:0xf bound_ctrl:0
    v_add_f32_dpp v31, v77, v76 row_shl:4 row_mask:0xf bank_mask:0xf bound_ctrl:0
    v_add_f32_dpp v32, v81, v80 row_shl:4 row_mask:0xf bank_mask:0xf bound_ctrl:0
    v_add_f32_dpp v33, v85, v84 row_shl:4 row_mask:0xf bank_mask:0xf bound_ctrl:0
    v_add_f32_dpp v34, v89, v88 row_shl:4 row_mask:0xf bank_mask:0xf bound_ctrl:0
    v_add_f32_dpp v35, v93, v92 row_shl:4 row_mask:0xf bank_mask:0xf bound_ctrl:0
    v_add_f32_dpp v28, v66, v28 row_shl:8 row_mask:0xf bank_mask:0xf bound_ctrl:0
    v_add_f32_dpp v29, v70, v29 row_shl:8 row_mask:0xf bank_mask:0xf bound_ctrl:0
    v_add_f32_dpp v30, v74, v30 row_shl:8 row_mask:0xf bank_mask:0xf bound_ctrl:0
    v_add_f32_dpp v31, v78, v31 row_shl:8 row_mask:0xf bank_mask:0xf bound_ctrl:0
    v_add_f32_dpp v32, v82, v32 row_shl:8 row_mask:0xf bank_mask:0xf bound_ctrl:0
    v_add_f32_dpp v33, v86, v33 row_shl:8 row_mask:0xf bank_mask:0xf bound_ctrl:0
    v_add_f32_dpp v34, v90, v34 row_shl:8 row_mask:0xf bank_mask:0xf bound_ctrl:0
    v_add_f32_dpp v35, v94, v35 row_shl:8 row_mask:0xf bank_mask:0xf bound_ctrl:0
    v_add_f32_dpp v28, v67, v28 row_shl:12 row_mask:0xf bank_mask:0xf bound_ctrl:0
    v_add_f32_dpp v29, v71, v29 row_shl:12 row_mask:0xf bank_mask:0xf bound_ctrl:0
    v_add_f32_dpp v30, v75, v30 row_shl:12 row_mask:0xf bank_mask:0xf bound_ctrl:0
    v_add_f32_dpp v31, v79, v31 row_shl:12 row_mask:0xf bank_mask:0xf bound_ctrl:0
    v_add_f32_dpp v32, v83, v32 row_shl:12 row_mask:0xf bank_mask:0xf bound_ctrl:0
    v_add_f32_dpp v33, v87, v33 row_shl:12 row_mask:0xf bank_mask:0xf bound_ctrl:0
    v_add_f32_dpp v34, v91, v34 row_shl:12 row_mask:0xf bank_mask:0xf bound_ctrl:0
    v_add_f32_dpp v35, v95, v35 row_shl:12 row_mask:0xf bank_mask:0xf bound_ctrl:0
    s_waitcnt vmcnt(2)
    buffer_load_dwordx4 v[252:255], v2, s[44:47], s12 offen offset:3072 nt
    s_waitcnt vmcnt(2)
    s_add_u32 s12, s100, 0
    s_and_b32 s12, s12, 229376
    buffer_load_dwordx4 v[96:99], v3, s[48:51], s12 offen offset:0 nt
    v_mfma_f32_16x16x32_bf16 v[64:67], v[160:163], v[60:63], 0
    v_mfma_f32_16x16x32_bf16 v[68:71], v[164:167], v[60:63], 0
    v_mfma_f32_16x16x32_bf16 v[72:75], v[168:171], v[60:63], 0
    v_mfma_f32_16x16x32_bf16 v[76:79], v[172:175], v[60:63], 0
    v_mfma_f32_16x16x32_bf16 v[80:83], v[176:179], v[60:63], 0
    v_mfma_f32_16x16x32_bf16 v[84:87], v[180:183], v[60:63], 0
    v_mfma_f32_16x16x32_bf16 v[88:91], v[184:187], v[60:63], 0
    v_mfma_f32_16x16x32_bf16 v[92:95], v[188:191], v[60:63], 0
    s_nop 0
    v_add_f32_dpp v36, v65, v64 row_shl:4 row_mask:0xf bank_mask:0xf bound_ctrl:0
    v_add_f32_dpp v37, v69, v68 row_shl:4 row_mask:0xf bank_mask:0xf bound_ctrl:0
    v_add_f32_dpp v38, v73, v72 row_shl:4 row_mask:0xf bank_mask:0xf bound_ctrl:0
    v_add_f32_dpp v39, v77, v76 row_shl:4 row_mask:0xf bank_mask:0xf bound_ctrl:0
    v_add_f32_dpp v40, v81, v80 row_shl:4 row_mask:0xf bank_mask:0xf bound_ctrl:0
    v_add_f32_dpp v41, v85, v84 row_shl:4 row_mask:0xf bank_mask:0xf bound_ctrl:0
    v_add_f32_dpp v42, v89, v88 row_shl:4 row_mask:0xf bank_mask:0xf bound_ctrl:0
    v_add_f32_dpp v43, v93, v92 row_shl:4 row_mask:0xf bank_mask:0xf bound_ctrl:0
    v_add_f32_dpp v36, v66, v36 row_shl:8 row_mask:0xf bank_mask:0xf bound_ctrl:0
    v_add_f32_dpp v37, v70, v37 row_shl:8 row_mask:0xf bank_mask:0xf bound_ctrl:0
    v_add_f32_dpp v38, v74, v38 row_shl:8 row_mask:0xf bank_mask:0xf bound_ctrl:0
    v_add_f32_dpp v39, v78, v39 row_shl:8 row_mask:0xf bank_mask:0xf bound_ctrl:0
    v_add_f32_dpp v40, v82, v40 row_shl:8 row_mask:0xf bank_mask:0xf bound_ctrl:0
    v_add_f32_dpp v41, v86, v41 row_shl:8 row_mask:0xf bank_mask:0xf bound_ctrl:0
    v_add_f32_dpp v42, v90, v42 row_shl:8 row_mask:0xf bank_mask:0xf bound_ctrl:0
    v_add_f32_dpp v43, v94, v43 row_shl:8 row_mask:0xf bank_mask:0xf bound_ctrl:0
    v_add_f32_dpp v36, v67, v36 row_shl:12 row_mask:0xf bank_mask:0xf bound_ctrl:0
    v_add_f32_dpp v37, v71, v37 row_shl:12 row_mask:0xf bank_mask:0xf bound_ctrl:0
    v_add_f32_dpp v38, v75, v38 row_shl:12 row_mask:0xf bank_mask:0xf bound_ctrl:0
    v_add_f32_dpp v39, v79, v39 row_shl:12 row_mask:0xf bank_mask:0xf bound_ctrl:0
    v_add_f32_dpp v40, v83, v40 row_shl:12 row_mask:0xf bank_mask:0xf bound_ctrl:0
    v_add_f32_dpp v41, v87, v41 row_shl:12 row_mask:0xf bank_mask:0xf bound_ctrl:0
    v_add_f32_dpp v42, v91, v42 row_shl:12 row_mask:0xf bank_mask:0xf bound_ctrl:0
    v_add_f32_dpp v43, v95, v43 row_shl:12 row_mask:0xf bank_mask:0xf bound_ctrl:0
    s_waitcnt vmcnt(2)
    buffer_load_dwordx4 v[100:103], v3, s[48:51], s12 offen offset:1024 nt
    s_waitcnt vmcnt(2)
    buffer_load_dwordx4 v[104:107], v3, s[48:51], s12 offen offset:2048 nt
    v_mfma_f32_16x16x32_bf16 v[64:67], v[192:195], v[60:63], 0
    v_mfma_f32_16x16x32_bf16 v[68:71], v[196:199], v[60:63], 0
    v_mfma_f32_16x16x32_bf16 v[72:75], v[200:203], v[60:63], 0
    v_mfma_f32_16x16x32_bf16 v[76:79], v[204:207], v[60:63], 0
    v_mfma_f32_16x16x32_bf16 v[80:83], v[208:211], v[60:63], 0
    v_mfma_f32_16x16x32_bf16 v[84:87], v[212:215], v[60:63], 0
    v_mfma_f32_16x16x32_bf16 v[88:91], v[216:219], v[60:63], 0
    v_mfma_f32_16x16x32_bf16 v[92:95], v[220:223], v[60:63], 0
    s_nop 0
    v_add_f32_dpp v44, v65, v64 row_shl:4 row_mask:0xf bank_mask:0xf bound_ctrl:0
    v_add_f32_dpp v45, v69, v68 row_shl:4 row_mask:0xf bank_mask:0xf bound_ctrl:0
    v_add_f32_dpp v46, v73, v72 row_shl:4 row_mask:0xf bank_mask:0xf bound_ctrl:0
    v_add_f32_dpp v47, v77, v76 row_shl:4 row_mask:0xf bank_mask:0xf bound_ctrl:0
    v_add_f32_dpp v48, v81, v80 row_shl:4 row_mask:0xf bank_mask:0xf bound_ctrl:0
    v_add_f32_dpp v49, v85, v84 row_shl:4 row_mask:0xf bank_mask:0xf bound_ctrl:0
    v_add_f32_dpp v50, v89, v88 row_shl:4 row_mask:0xf bank_mask:0xf bound_ctrl:0
    v_add_f32_dpp v51, v93, v92 row_shl:4 row_mask:0xf bank_mask:0xf bound_ctrl:0
    v_add_f32_dpp v44, v66, v44 row_shl:8 row_mask:0xf bank_mask:0xf bound_ctrl:0
    v_add_f32_dpp v45, v70, v45 row_shl:8 row_mask:0xf bank_mask:0xf bound_ctrl:0
    v_add_f32_dpp v46, v74, v46 row_shl:8 row_mask:0xf bank_mask:0xf bound_ctrl:0
    v_add_f32_dpp v47, v78, v47 row_shl:8 row_mask:0xf bank_mask:0xf bound_ctrl:0
    v_add_f32_dpp v48, v82, v48 row_shl:8 row_mask:0xf bank_mask:0xf bound_ctrl:0
    v_add_f32_dpp v49, v86, v49 row_shl:8 row_mask:0xf bank_mask:0xf bound_ctrl:0
    v_add_f32_dpp v50, v90, v50 row_shl:8 row_mask:0xf bank_mask:0xf bound_ctrl:0
    v_add_f32_dpp v51, v94, v51 row_shl:8 row_mask:0xf bank_mask:0xf bound_ctrl:0
    v_add_f32_dpp v44, v67, v44 row_shl:12 row_mask:0xf bank_mask:0xf bound_ctrl:0
    v_add_f32_dpp v45, v71, v45 row_shl:12 row_mask:0xf bank_mask:0xf bound_ctrl:0
    v_add_f32_dpp v46, v75, v46 row_shl:12 row_mask:0xf bank_mask:0xf bound_ctrl:0
    v_add_f32_dpp v47, v79, v47 row_shl:12 row_mask:0xf bank_mask:0xf bound_ctrl:0
    v_add_f32_dpp v48, v83, v48 row_shl:12 row_mask:0xf bank_mask:0xf bound_ctrl:0
    v_add_f32_dpp v49, v87, v49 row_shl:12 row_mask:0xf bank_mask:0xf bound_ctrl:0
    v_add_f32_dpp v50, v91, v50 row_shl:12 row_mask:0xf bank_mask:0xf bound_ctrl:0
    v_add_f32_dpp v51, v95, v51 row_shl:12 row_mask:0xf bank_mask:0xf bound_ctrl:0
    s_waitcnt vmcnt(2)
    buffer_load_dwordx4 v[108:111], v3, s[48:51], s12 offen offset:3072 nt
    s_waitcnt vmcnt(2)
    s_add_u32 s12, s100, 32768
    s_and_b32 s12, s12, 229376
    buffer_load_dwordx4 v[112:115], v3, s[48:51], s12 offen offset:0 nt
    v_mfma_f32_16x16x32_bf16 v[64:67], v[224:227], v[60:63], 0
    v_mfma_f32_16x16x32_bf16 v[68:71], v[228:231], v[60:63], 0
    v_mfma_f32_16x16x32_bf16 v[72:75], v[232:235], v[60:63], 0
    v_mfma_f32_16x16x32_bf16 v[76:79], v[236:239], v[60:63], 0
    v_mfma_f32_16x16x32_bf16 v[80:83], v[240:243], v[60:63], 0
    v_mfma_f32_16x16x32_bf16 v[84:87], v[244:247], v[60:63], 0
    v_mfma_f32_16x16x32_bf16 v[88:91], v[248:251], v[60:63], 0
    v_mfma_f32_16x16x32_bf16 v[92:95], v[252:255], v[60:63], 0
    s_nop 0
    v_add_f32_dpp v52, v65, v64 row_shl:4 row_mask:0xf bank_mask:0xf bound_ctrl:0
    v_add_f32_dpp v53, v69, v68 row_shl:4 row_mask:0xf bank_mask:0xf bound_ctrl:0
    v_add_f32_dpp v54, v73, v72 row_shl:4 row_mask:0xf bank_mask:0xf bound_ctrl:0
    v_add_f32_dpp v55, v77, v76 row_shl:4 row_mask:0xf bank_mask:0xf bound_ctrl:0
    v_add_f32_dpp v56, v81, v80 row_shl:4 row_mask:0xf bank_mask:0xf bound_ctrl:0
    v_add_f32_dpp v57, v85, v84 row_shl:4 row_mask:0xf bank_mask:0xf bound_ctrl:0
    v_add_f32_dpp v58, v89, v88 row_shl:4 row_mask:0xf bank_mask:0xf bound_ctrl:0
    v_add_f32_dpp v59, v93, v92 row_shl:4 row_mask:0xf bank_mask:0xf bound_ctrl:0
    v_add_f32_dpp v52, v66, v52 row_shl:8 row_mask:0xf bank_mask:0xf bound_ctrl:0
    v_add_f32_dpp v53, v70, v53 row_shl:8 row_mask:0xf bank_mask:0xf bound_ctrl:0
    v_add_f32_dpp v54, v74, v54 row_shl:8 row_mask:0xf bank_mask:0xf bound_ctrl:0
    v_add_f32_dpp v55, v78, v55 row_shl:8 row_mask:0xf bank_mask:0xf bound_ctrl:0
    v_add_f32_dpp v56, v82, v56 row_shl:8 row_mask:0xf bank_mask:0xf bound_ctrl:0
    v_add_f32_dpp v57, v86, v57 row_shl:8 row_mask:0xf bank_mask:0xf bound_ctrl:0
    v_add_f32_dpp v58, v90, v58 row_shl:8 row_mask:0xf bank_mask:0xf bound_ctrl:0
    v_add_f32_dpp v59, v94, v59 row_shl:8 row_mask:0xf bank_mask:0xf bound_ctrl:0
    v_add_f32_dpp v52, v67, v52 row_shl:12 row_mask:0xf bank_mask:0xf bound_ctrl:0
    v_add_f32_dpp v53, v71, v53 row_shl:12 row_mask:0xf bank_mask:0xf bound_ctrl:0
    v_add_f32_dpp v54, v75, v54 row_shl:12 row_mask:0xf bank_mask:0xf bound_ctrl:0
    v_add_f32_dpp v55, v79, v55 row_shl:12 row_mask:0xf bank_mask:0xf bound_ctrl:0
    v_add_f32_dpp v56, v83, v56 row_shl:12 row_mask:0xf bank_mask:0xf bound_ctrl:0
    v_add_f32_dpp v57, v87, v57 row_shl:12 row_mask:0xf bank_mask:0xf bound_ctrl:0
    v_add_f32_dpp v58, v91, v58 row_shl:12 row_mask:0xf bank_mask:0xf bound_ctrl:0
    v_add_f32_dpp v59, v95, v59 row_shl:12 row_mask:0xf bank_mask:0xf bound_ctrl:0
    v_max3_f32 v64, v28, v29, v30
    v_max3_f32 v65, v31, v32, v33
    v_max3_f32 v64, v64, v34, v35
    v_max3_f32 v65, v65, v36, v37
    v_max3_f32 v64, v64, v38, v39
    v_max3_f32 v65, v65, v40, v41
    v_max3_f32 v64, v64, v42, v43
    v_max3_f32 v65, v65, v44, v45
    v_max3_f32 v64, v64, v46, v47
    v_max3_f32 v65, v65, v48, v49
    v_max3_f32 v64, v64, v50, v51
    v_max3_f32 v65, v65, v52, v53
    v_max3_f32 v64, v64, v54, v55
    v_max3_f32 v65, v65, v56, v57
    v_max3_f32 v64, v64, v58, v59
    v_max_f32 v64, v64, v65
    s_mov_b64 exec, s[64:65]
    ds_max_f32 v5, v64 offset:1568
    s_mov_b64 exec, -1
    s_waitcnt vmcnt(2)
    buffer_load_dwordx4 v[116:119], v3, s[48:51], s12 offen offset:1024 nt
    s_lshl_b32 s8, s7, 5
    s_and_b32 s9, s5, 1
    s_lshl_b32 s9, s9, 4
    s_add_u32 s14, s8, s9
    s_cmp_ge_u32 s3, 1
    s_cbranch_scc1 L_nob2
    s_load_dwordx4 s[96:99], s[34:35], s14
L_nob2:
    s_bfe_u32 s71, s5, 0x20001
    s_waitcnt lgkmcnt(0)
    s_barrier
    ds_read_b32 v228, v5 offset:1568
    s_waitcnt vmcnt(2)
    buffer_load_dwordx4 v[120:123], v3, s[48:51], s12 offen offset:2048 nt
    s_waitcnt vmcnt(2)
    buffer_load_dwordx4 v[124:127], v3, s[48:51], s12 offen offset:3072 nt
    v_mul_u32_u24 v229, 136, v5
    v_lshrrev_b32 v230, 4, v1
    v_lshl_add_u32 v229, v230, 7, v229
    s_mul_i32 s8, s3, 2176
    s_add_u32 s8, s8, 2688
    v_add_u32 v229, s8, v229
    v_and_b32 v225, 12, v1
    v_lshl_add_u32 v229, v225, 2, v229
    s_waitcnt lgkmcnt(0)
    v_mul_f32 v228, s68, v228
    v_fma_f32 v28, v28, s68, -v228
    v_fma_f32 v29, v29, s68, -v228
    v_fma_f32 v30, v30, s68, -v228
    v_fma_f32 v31, v31, s68, -v228
    v_fma_f32 v32, v32, s68, -v228
    v_fma_f32 v33, v33, s68, -v228
    v_fma_f32 v34, v34, s68, -v228
    v_fma_f32 v35, v35, s68, -v228
    v_exp_f32 v28, v28
    v_exp_f32 v29, v29
    v_exp_f32 v30, v30
    v_exp_f32 v31, v31
    v_exp_f32 v32, v32
    v_exp_f32 v33, v33
    v_exp_f32 v34, v34
    v_exp_f32 v35, v35
    s_nop 0
    v_cvt_pk_bf16_f32 v12, v28, v29
    v_cvt_pk_bf16_f32 v13, v30, v31
    v_cvt_pk_bf16_f32 v14, v32, v33
    v_cvt_pk_bf16_f32 v15, v34, v35
    s_waitcnt vmcnt(2)
    s_add_u32 s12, s100, 65536
    s_and_b32 s12, s12, 229376
    buffer_load_dwordx4 v[128:131], v3, s[48:51], s12 offen offset:0 nt
    v_fma_f32 v36, v36, s68, -v228
    v_fma_f32 v37, v37, s68, -v228
    v_fma_f32 v38, v38, s68, -v228
    v_fma_f32 v39, v39, s68, -v228
    v_fma_f32 v40, v40, s68, -v228
    v_fma_f32 v41, v41, s68, -v228
    v_fma_f32 v42, v42, s68, -v228
    v_fma_f32 v43, v43, s68, -v228
    v_exp_f32 v36, v36
    v_exp_f32 v37, v37
    v_exp_f32 v38, v38
    v_exp_f32 v39, v39
    v_exp_f32 v40, v40
    v_exp_f32 v41, v41
    v_exp_f32 v42, v42
    v_exp_f32 v43, v43
    s_nop 0
    v_cvt_pk_bf16_f32 v16, v36, v37
    v_cvt_pk_bf16_f32 v17, v38, v39
    v_cvt_pk_bf16_f32 v18, v40, v41
    v_cvt_pk_bf16_f32 v19, v42, v43
    s_waitcnt vmcnt(2)
    buffer_load_dwordx4 v[132:135], v3, s[48:51], s12 offen offset:1024 nt
    v_fma_f32 v44, v44, s68, -v228
    v_fma_f32 v45, v45, s68, -v228
    v_fma_f32 v46, v46, s68, -v228
    v_fma_f32 v47, v47, s68, -v228
    v_fma_f32 v48, v48, s68, -v228
    v_fma_f32 v49, v49, s68, -v228
    v_fma_f32 v50, v50, s68, -v228
    v_fma_f32 v51, v51, s68, -v228
    v_exp_f32 v44, v44
    v_exp_f32 v45, v45
    v_exp_f32 v46, v46
    v_exp_f32 v47, v47
    v_exp_f32 v48, v48
    v_exp_f32 v49, v49
    v_exp_f32 v50, v50
    v_exp_f32 v51, v51
    s_nop 0
    v_cvt_pk_bf16_f32 v20, v44, v45
    v_cvt_pk_bf16_f32 v21, v46, v47
    v_cvt_pk_bf16_f32 v22, v48, v49
    v_cvt_pk_bf16_f32 v23, v50, v51
    s_waitcnt vmcnt(2)
    buffer_load_dwordx4 v[136:139], v3, s[48:51], s12 offen offset:2048 nt
    v_fma_f32 v52, v52, s68, -v228
    v_fma_f32 v53, v53, s68, -v228
    v_fma_f32 v54, v54, s68, -v228
    v_fma_f32 v55, v55, s68, -v228
    v_fma_f32 v56, v56, s68, -v228
    v_fma_f32 v57, v57, s68, -v228
    v_fma_f32 v58, v58, s68, -v228
    v_fma_f32 v59, v59, s68, -v228
    v_exp_f32 v52, v52
    v_exp_f32 v53, v53
    v_exp_f32 v54, v54
    v_exp_f32 v55, v55
    v_exp_f32 v56, v56
    v_exp_f32 v57, v57
    v_exp_f32 v58, v58
    v_exp_f32 v59, v59
    s_nop 0
    v_cvt_pk_bf16_f32 v24, v52, v53
    v_cvt_pk_bf16_f32 v25, v54, v55
    v_cvt_pk_bf16_f32 v26, v56, v57
    v_cvt_pk_bf16_f32 v27, v58, v59
    s_waitcnt vmcnt(2)
    buffer_load_dwordx4 v[140:143], v3, s[48:51], s12 offen offset:3072 nt
    s_and_b32 s8, s3, 3
    v_and_b32 v246, 0xf0, v3
    v_mul_u32_u24 v231, 4352, v230
    v_add_u32 v231, v231, v246
    s_mul_i32 s9, s8, 544
    s_add_u32 s11, s9, 2688
    v_add_u32 v231, s11, v231
    v_and_b32 v232, 7, v1
    v_mul_u32_u24 v232, 2176, v232
    s_add_u32 s9, s9, 3200
    v_add_u32 v232, s9, v232
    v_readlane_b32 s9, v228, s8
    v_and_b32 v233, 32, v1
    v_lshl_add_u32 v233, v233, 3, v246
    v_and_b32 v225, 1, v230
    v_lshl_add_u32 v233, v225, 3, v233
    s_lshl_b32 s11, s8, 9
    v_add_u32 v233, s11, v233
    s_mul_i32 s69, s4, 69632
    v_mov_b32 v251, s9
    v_lshlrev_b32 v250, 12, v251
    v_bfi_b32 v250, s70, v4, v250
    v_bfi_b32 v251, s70, v4, v251
    s_add_u32 s69, s69, 524288
    s_mul_i32 s26, s5, 2176
    s_add_u32 s26, s26, s69
    s_lshl4_add_u32 s60, s8, s26
    v_lshrrev_b32 v237, 3, v1
    s_lshl_b32 s11, s3, 3
    v_add_u32 v237, s11, v237
    v_mul_u32_u24 v237, 2176, v237
    v_and_b32 v238, 0x70, v3
    v_add_u32 v236, v238, v237
    s_lshl_b32 s11, s6, 9
    v_add_u32 v236, s11, v236
    s_lshl_b32 s11, s6, 4
    v_add_u32 v237, s11, v237
    s_waitcnt vmcnt(2)
    s_add_u32 s12, s100, 98304
    s_and_b32 s12, s12, 229376
    buffer_load_dwordx4 v[144:147], v3, s[48:51], s12 offen offset:0 nt
    v_lshrrev_b32 v238, 1, v238
    v_lshl_add_u32 v238, v230, 6, v238
    s_lshl_b32 s11, s3, 8
    v_add_u32 v238, s11, v238
    v_lshlrev_b32 v240, 4, v230
    v_lshl_add_u32 v239, v5, 6, v240
    v_lshl_add_u32 v243, v5, 4, v240
    v_lshl_add_u32 v240, v5, 5, v240
    v_bfe_u32 v225, v1, 2, 2
    s_and_b32 s9, s3, 3
    s_lshl_b32 s11, s9, 5
    v_lshl_add_u32 v242, v5, 1, s11
    v_lshlrev_b32 v241, 5, v225
    v_xor_b32 v242, v241, v242
    v_lshl_add_u32 v241, v225, 10, v242
    v_lshl_add_u32 v241, v230, 8, v241
    v_lshl_add_u32 v242, v225, 7, v242
    v_lshl_add_u32 v242, v230, 10, v242
    s_and_b32 s15, s5, 7
    s_lshl_b32 s27, s15, 5
    s_add_u32 s27, s27, s7
    s_lshl_b32 s27, s27, 2
    s_add_u32 s27, s27, s9
    s_lshl_b32 s27, s27, 8
    s_add_u32 s27, s27, 1114112
    v_lshlrev_b32 v245, 1, v5
    s_waitcnt vmcnt(2)
    buffer_load_dwordx4 v[148:151], v3, s[48:51], s12 offen offset:1024 nt
    v_lshrrev_b32 v244, 1, v1
    v_lshlrev_b32 v244, 10, v244
    v_and_b32 v225, 1, v1
    v_lshl_add_u32 v244, v225, 4, v244
    s_lshl_b32 s61, s4, 10
    s_add_u32 s61, s61, s5
    s_lshl_b32 s61, s61, 5
    s_add_u32 s61, s61, 1114112
    v_lshlrev_b32 v226, 3, v225
    v_lshl_add_u32 v226, v230, 1, v226
    s_lshl_b32 s11, s71, 10
    s_add_u32 s11, s11, s14
    v_add_u32 v226, s11, v226
    s_lshl_b32 s11, s96, 16
    v_writelane_b32 v227, s11, 0
    s_and_b32 s11, s96, 0xffff0000
    v_writelane_b32 v227, s11, 16
    s_lshl_b32 s11, s97, 16
    v_writelane_b32 v227, s11, 32
    s_and_b32 s11, s97, 0xffff0000
    v_writelane_b32 v227, s11, 48
    s_lshl_b32 s11, s98, 16
    v_writelane_b32 v227, s11, 1
    s_and_b32 s11, s98, 0xffff0000
    v_writelane_b32 v227, s11, 17
    s_lshl_b32 s11, s99, 16
    v_writelane_b32 v227, s11, 33
    s_and_b32 s11, s99, 0xffff0000
    v_writelane_b32 v227, s11, 49
    ds_read_b32 v225, v245 offset:1540
    s_waitcnt lgkmcnt(0)
    v_readlane_b32 s8, v225, s71
    s_nop 1
    v_mul_f32 v227, s8, v227
    s_and_b32 s11, s3, 3
    s_lshl_b32 s96, s7, 17
    s_lshl_b32 s9, s15, 7
    s_lshl_b32 s10, s11, 15
    s_add_u32 s96, s96, s10
    s_add_u32 s96, s96, s9
    s_mov_b32 s56, s24
    s_mov_b32 s57, s25
    s_mov_b32 s58, 4194304
    s_mov_b32 s59, 0x20000
    v_lshrrev_b32 v7, 3, v1
    v_lshlrev_b32 v7, 10, v7
    v_and_b32 v6, 0x70, v3
    v_add_u32 v7, v6, v7
    v_bfe_u32 v249, v1, 3, 2
    v_lshlrev_b32 v249, 5, v249
    v_xor_b32 v249, v249, v7
    v_xor_b32 v6, 32, v7
    v_add_u32 v6, 8192, v6
    v_xor_b32 v247, 64, v7
    v_add_u32 v247, 16384, v247
    v_xor_b32 v248, 96, v7
    v_add_u32 v248, 24576, v248
    s_lshl_b32 s10, s11, 12
    s_add_u32 m0, s10, 20096
    s_mul_i32 s98, s7, 57344
    s_mov_b32 s44, s32
    s_mov_b32 s45, s33
    s_mov_b32 s46, 1835008
    s_lshl_b32 s10, s11, 11
    s_add_u32 s99, s10, 36480
    s_lshl_b32 s10, s11, 14
    s_add_u32 s98, s98, s10
    s_add_u32 s98, s98, s9
    s_add_u32 s97, s98, 8192
    v_perm_b32 v64, v100, v96, s66
    v_perm_b32 v68, v100, v96, s67
    v_perm_b32 v72, v101, v97, s66
    v_perm_b32 v76, v101, v97, s67
    v_perm_b32 v80, v102, v98, s66
    v_perm_b32 v84, v102, v98, s67
    v_perm_b32 v88, v103, v99, s66
    v_perm_b32 v92, v103, v99, s67
    v_perm_b32 v65, v108, v104, s66
    v_perm_b32 v69, v108, v104, s67
    v_perm_b32 v73, v109, v105, s66
    v_perm_b32 v77, v109, v105, s67
    v_perm_b32 v81, v110, v106, s66
    v_perm_b32 v85, v110, v106, s67
    v_perm_b32 v89, v111, v107, s66
    v_perm_b32 v93, v111, v107, s67
    v_perm_b32 v66, v116, v112, s66
    v_perm_b32 v70, v116, v112, s67
    v_perm_b32 v74, v117, v113, s66
    v_perm_b32 v78, v117, v113, s67
    v_perm_b32 v82, v118, v114, s66
    v_perm_b32 v86, v118, v114, s67
    v_perm_b32 v90, v119, v115, s66
    v_perm_b32 v94, v119, v115, s67
    v_perm_b32 v67, v124, v120, s66
    v_perm_b32 v71, v124, v120, s67
    v_perm_b32 v75, v125, v121, s66
    v_perm_b32 v79, v125, v121, s67
    v_perm_b32 v83, v126, v122, s66
    v_perm_b32 v87, v126, v122, s67
    v_perm_b32 v91, v127, v123, s66
    v_perm_b32 v95, v127, v123, s67
    v_mfma_f32_16x16x32_bf16 v[60:63], v[8:11], v[12:15], 0
    s_nop 0
    v_mfma_f32_16x16x32_bf16 v[28:31], v[64:67], v[12:15], 0
    v_mfma_f32_16x16x32_bf16 v[32:35], v[68:71], v[12:15], 0
    v_mfma_f32_16x16x32_bf16 v[36:39], v[72:75], v[12:15], 0
    v_mfma_f32_16x16x32_bf16 v[40:43], v[76:79], v[12:15], 0
    v_mfma_f32_16x16x32_bf16 v[44:47], v[80:83], v[12:15], 0
    v_mfma_f32_16x16x32_bf16 v[48:51], v[84:87], v[12:15], 0
    v_mfma_f32_16x16x32_bf16 v[52:55], v[88:91], v[12:15], 0
    v_mfma_f32_16x16x32_bf16 v[56:59], v[92:95], v[12:15], 0
    s_waitcnt vmcnt(2)
    buffer_load_dwordx4 v[152:155], v3, s[48:51], s12 offen offset:2048 nt
    s_waitcnt vmcnt(2)
    buffer_load_dwordx4 v[156:159], v3, s[48:51], s12 offen offset:3072 nt
    s_waitcnt vmcnt(2)
    s_add_u32 s12, s100, 131072
    s_and_b32 s12, s12, 229376
    buffer_load_dwordx4 v[160:163], v3, s[48:51], s12 offen offset:0 nt
    s_waitcnt vmcnt(2)
    buffer_load_dwordx4 v[164:167], v3, s[48:51], s12 offen offset:1024 nt
    s_waitcnt vmcnt(2)
    buffer_load_dwordx4 v[168:171], v3, s[48:51], s12 offen offset:2048 nt
    v_perm_b32 v64, v132, v128, s66
    v_perm_b32 v68, v132, v128, s67
    v_perm_b32 v72, v133, v129, s66
    v_perm_b32 v76, v133, v129, s67
    v_perm_b32 v80, v134, v130, s66
    v_perm_b32 v84, v134, v130, s67
    v_perm_b32 v88, v135, v131, s66
    v_perm_b32 v92, v135, v131, s67
    v_perm_b32 v65, v140, v136, s66
    v_perm_b32 v69, v140, v136, s67
    v_perm_b32 v73, v141, v137, s66
    v_perm_b32 v77, v141, v137, s67
    v_perm_b32 v81, v142, v138, s66
    v_perm_b32 v85, v142, v138, s67
    v_perm_b32 v89, v143, v139, s66
    v_perm_b32 v93, v143, v139, s67
    v_perm_b32 v66, v148, v144, s66
    v_perm_b32 v70, v148, v144, s67
    v_perm_b32 v74, v149, v145, s66
    v_perm_b32 v78, v149, v145, s67
    v_perm_b32 v82, v150, v146, s66
    v_perm_b32 v86, v150, v146, s67
    v_perm_b32 v90, v151, v147, s66
    v_perm_b32 v94, v151, v147, s67
    v_perm_b32 v67, v156, v152, s66
    v_perm_b32 v71, v156, v152, s67
    v_perm_b32 v75, v157, v153, s66
    v_perm_b32 v79, v157, v153, s67
    v_perm_b32 v83, v158, v154, s66
    v_perm_b32 v87, v158, v154, s67
    v_perm_b32 v91, v159, v155, s66
    v_perm_b32 v95, v159, v155, s67
    v_mfma_f32_16x16x32_bf16 v[60:63], v[8:11], v[16:19], v[60:63]
    s_nop 0
    v_mfma_f32_16x16x32_bf16 v[28:31], v[64:67], v[16:19], v[28:31]
    v_mfma_f32_16x16x32_bf16 v[32:35], v[68:71], v[16:19], v[32:35]
    v_mfma_f32_16x16x32_bf16 v[36:39], v[72:75], v[16:19], v[36:39]
    v_mfma_f32_16x16x32_bf16 v[40:43], v[76:79], v[16:19], v[40:43]
    v_mfma_f32_16x16x32_bf16 v[44:47], v[80:83], v[16:19], v[44:47]
    v_mfma_f32_16x16x32_bf16 v[48:51], v[84:87], v[16:19], v[48:51]
    v_mfma_f32_16x16x32_bf16 v[52:55], v[88:91], v[16:19], v[52:55]
    v_mfma_f32_16x16x32_bf16 v[56:59], v[92:95], v[16:19], v[56:59]
    s_waitcnt vmcnt(2)
    buffer_load_dwordx4 v[172:175], v3, s[48:51], s12 offen offset:3072 nt
    s_waitcnt vmcnt(2)
    s_add_u32 s12, s100, 163840
    s_and_b32 s12, s12, 229376
    buffer_load_dwordx4 v[176:179], v3, s[48:51], s12 offen offset:0 nt
    s_waitcnt vmcnt(2)
    buffer_load_dwordx4 v[180:183], v3, s[48:51], s12 offen offset:1024 nt
    s_waitcnt vmcnt(2)
    buffer_load_dwordx4 v[184:187], v3, s[48:51], s12 offen offset:2048 nt
    s_waitcnt vmcnt(2)
    buffer_load_dwordx4 v[188:191], v3, s[48:51], s12 offen offset:3072 nt
    s_waitcnt vmcnt(2)
    s_add_u32 s12, s100, 196608
    s_and_b32 s12, s12, 229376
    buffer_load_dwordx4 v[192:195], v3, s[48:51], s12 offen offset:0 nt
    s_waitcnt vmcnt(2)
    buffer_load_dwordx4 v[196:199], v3, s[48:51], s12 offen offset:1024 nt
    s_waitcnt vmcnt(2)
    buffer_load_dwordx4 v[200:203], v3, s[48:51], s12 offen offset:2048 nt
    s_waitcnt vmcnt(2)
    buffer_load_dwordx4 v[204:207], v3, s[48:51], s12 offen offset:3072 nt
    v_perm_b32 v64, v164, v160, s66
    v_perm_b32 v68, v164, v160, s67
    v_perm_b32 v72, v165, v161, s66
    v_perm_b32 v76, v165, v161, s67
    v_perm_b32 v80, v166, v162, s66
    v_perm_b32 v84, v166, v162, s67
    v_perm_b32 v88, v167, v163, s66
    v_perm_b32 v92, v167, v163, s67
    v_perm_b32 v65, v172, v168, s66
    v_perm_b32 v69, v172, v168, s67
    v_perm_b32 v73, v173, v169, s66
    v_perm_b32 v77, v173, v169, s67
    v_perm_b32 v81, v174, v170, s66
    v_perm_b32 v85, v174, v170, s67
    v_perm_b32 v89, v175, v171, s66
    v_perm_b32 v93, v175, v171, s67
    v_perm_b32 v66, v180, v176, s66
    v_perm_b32 v70, v180, v176, s67
    v_perm_b32 v74, v181, v177, s66
    v_perm_b32 v78, v181, v177, s67
    v_perm_b32 v82, v182, v178, s66
    v_perm_b32 v86, v182, v178, s67
    v_perm_b32 v90, v183, v179, s66
    v_perm_b32 v94, v183, v179, s67
    v_perm_b32 v67, v188, v184, s66
    v_perm_b32 v71, v188, v184, s67
    v_perm_b32 v75, v189, v185, s66
    v_perm_b32 v79, v189, v185, s67
    v_perm_b32 v83, v190, v186, s66
    v_perm_b32 v87, v190, v186, s67
    v_perm_b32 v91, v191, v187, s66
    v_perm_b32 v95, v191, v187, s67
    v_mfma_f32_16x16x32_bf16 v[60:63], v[8:11], v[20:23], v[60:63]
    s_nop 0
    v_mfma_f32_16x16x32_bf16 v[28:31], v[64:67], v[20:23], v[28:31]
    v_mfma_f32_16x16x32_bf16 v[32:35], v[68:71], v[20:23], v[32:35]
    v_mfma_f32_16x16x32_bf16 v[36:39], v[72:75], v[20:23], v[36:39]
    v_mfma_f32_16x16x32_bf16 v[40:43], v[76:79], v[20:23], v[40:43]
    v_mfma_f32_16x16x32_bf16 v[44:47], v[80:83], v[20:23], v[44:47]
    v_mfma_f32_16x16x32_bf16 v[48:51], v[84:87], v[20:23], v[48:51]
    v_mfma_f32_16x16x32_bf16 v[52:55], v[88:91], v[20:23], v[52:55]
    v_mfma_f32_16x16x32_bf16 v[56:59], v[92:95], v[20:23], v[56:59]
    s_waitcnt vmcnt(2)
    s_add_u32 s12, s100, 229376
    s_and_b32 s12, s12, 229376
    buffer_load_dwordx4 v[208:211], v3, s[48:51], s12 offen offset:0 nt
    s_waitcnt vmcnt(2)
    buffer_load_dwordx4 v[212:215], v3, s[48:51], s12 offen offset:1024 nt
    s_waitcnt vmcnt(2)
    buffer_load_dwordx4 v[216:219], v3, s[48:51], s12 offen offset:2048 nt
    s_waitcnt vmcnt(2)
    buffer_load_dwordx4 v[220:223], v3, s[48:51], s12 offen offset:3072 nt
    v_perm_b32 v64, v196, v192, s66
    v_perm_b32 v68, v196, v192, s67
    v_perm_b32 v72, v197, v193, s66
    v_perm_b32 v76, v197, v193, s67
    v_perm_b32 v80, v198, v194, s66
    v_perm_b32 v84, v198, v194, s67
    v_perm_b32 v88, v199, v195, s66
    v_perm_b32 v92, v199, v195, s67
    v_perm_b32 v65, v204, v200, s66
    v_perm_b32 v69, v204, v200, s67
    v_perm_b32 v73, v205, v201, s66
    v_perm_b32 v77, v205, v201, s67
    v_perm_b32 v81, v206, v202, s66
    v_perm_b32 v85, v206, v202, s67
    v_perm_b32 v89, v207, v203, s66
    v_perm_b32 v93, v207, v203, s67
    s_waitcnt vmcnt(2)
    s_cmp_lt_u32 s3, 4
    s_cbranch_scc1 L_ws0
    buffer_load_dwordx4 v7, s[56:59], s96 offen nt lds
    s_add_u32 m0, m0, 1024
    s_nop 0
    buffer_load_dwordx4 v6, s[56:59], s96 offen nt lds
    s_add_u32 m0, m0, 1024
    s_nop 0
L_ws0:
    v_perm_b32 v66, v212, v208, s66
    v_perm_b32 v70, v212, v208, s67
    v_perm_b32 v74, v213, v209, s66
    v_perm_b32 v78, v213, v209, s67
    v_perm_b32 v82, v214, v210, s66
    v_perm_b32 v86, v214, v210, s67
    v_perm_b32 v90, v215, v211, s66
    v_perm_b32 v94, v215, v211, s67
    s_cbranch_scc1 L_ws1
    s_waitcnt vmcnt(3)
    buffer_load_dwordx4 v247, s[56:59], s96 offen nt lds
    s_add_u32 m0, m0, 1024
    s_nop 0
    buffer_load_dwordx4 v248, s[56:59], s96 offen nt lds
    s_mov_b32 m0, s99
    s_nop 0
    s_waitcnt vmcnt(4)
    buffer_load_dwordx4 v249, s[44:47], s98 offen nt lds
    s_add_u32 m0, m0, 1024
    s_nop 0
    buffer_load_dwordx4 v249, s[44:47], s97 offen nt lds
    s_branch L_ws2
L_ws1:
    s_waitcnt vmcnt(0)
L_ws2:
    v_perm_b32 v67, v220, v216, s66
    v_perm_b32 v71, v220, v216, s67
    v_perm_b32 v75, v221, v217, s66
    v_perm_b32 v79, v221, v217, s67
    v_perm_b32 v83, v222, v218, s66
    v_perm_b32 v87, v222, v218, s67
    v_perm_b32 v91, v223, v219, s66
    v_perm_b32 v95, v223, v219, s67
    v_mfma_f32_16x16x32_bf16 v[60:63], v[8:11], v[24:27], v[60:63]
    s_nop 0
    v_mfma_f32_16x16x32_bf16 v[28:31], v[64:67], v[24:27], v[28:31]
    v_mfma_f32_16x16x32_bf16 v[32:35], v[68:71], v[24:27], v[32:35]
    v_mfma_f32_16x16x32_bf16 v[36:39], v[72:75], v[24:27], v[36:39]
    v_mfma_f32_16x16x32_bf16 v[40:43], v[76:79], v[24:27], v[40:43]
    v_mfma_f32_16x16x32_bf16 v[44:47], v[80:83], v[24:27], v[44:47]
    v_mfma_f32_16x16x32_bf16 v[48:51], v[84:87], v[24:27], v[48:51]
    v_mfma_f32_16x16x32_bf16 v[52:55], v[88:91], v[24:27], v[52:55]
    v_mfma_f32_16x16x32_bf16 v[56:59], v[92:95], v[24:27], v[56:59]
    s_mov_b64 exec, 15
    ds_write_b32 v229, v60 offset:512
    s_mov_b64 exec, -1
    v_mov_b32_dpp v28, v32 row_shr:4 row_mask:0xf bank_mask:0x2
    v_mov_b32_dpp v29, v33 row_shr:4 row_mask:0xf bank_mask:0x2
    v_mov_b32_dpp v30, v34 row_shr:4 row_mask:0xf bank_mask:0x2
    v_mov_b32_dpp v31, v35 row_shr:4 row_mask:0xf bank_mask:0x2
    v_mov_b32_dpp v28, v36 row_shr:8 row_mask:0xf bank_mask:0x4
    v_mov_b32_dpp v29, v37 row_shr:8 row_mask:0xf bank_mask:0x4
    v_mov_b32_dpp v30, v38 row_shr:8 row_mask:0xf bank_mask:0x4
    v_mov_b32_dpp v31, v39 row_shr:8 row_mask:0xf bank_mask:0x4
    v_mov_b32_dpp v28, v40 row_shr:12 row_mask:0xf bank_mask:0x8
    v_mov_b32_dpp v29, v41 row_shr:12 row_mask:0xf bank_mask:0x8
    v_mov_b32_dpp v30, v42 row_shr:12 row_mask:0xf bank_mask:0x8
    v_mov_b32_dpp v31, v43 row_shr:12 row_mask:0xf bank_mask:0x8
    ds_write_b128 v229, v[28:31] offset:0
    v_mov_b32_dpp v44, v48 row_shr:4 row_mask:0xf bank_mask:0x2
    v_mov_b32_dpp v45, v49 row_shr:4 row_mask:0xf bank_mask:0x2
    v_mov_b32_dpp v46, v50 row_shr:4 row_mask:0xf bank_mask:0x2
    v_mov_b32_dpp v47, v51 row_shr:4 row_mask:0xf bank_mask:0x2
    v_mov_b32_dpp v44, v52 row_shr:8 row_mask:0xf bank_mask:0x4
    v_mov_b32_dpp v45, v53 row_shr:8 row_mask:0xf bank_mask:0x4
    v_mov_b32_dpp v46, v54 row_shr:8 row_mask:0xf bank_mask:0x4
    v_mov_b32_dpp v47, v55 row_shr:8 row_mask:0xf bank_mask:0x4
    v_mov_b32_dpp v44, v56 row_shr:12 row_mask:0xf bank_mask:0x8
    v_mov_b32_dpp v45, v57 row_shr:12 row_mask:0xf bank_mask:0x8
    v_mov_b32_dpp v46, v58 row_shr:12 row_mask:0xf bank_mask:0x8
    v_mov_b32_dpp v47, v59 row_shr:12 row_mask:0xf bank_mask:0x8
    ds_write_b128 v229, v[44:47] offset:64
    s_cmp_ge_u32 s3, 4
    s_waitcnt lgkmcnt(0)
    s_barrier
    s_cbranch_scc1 L_stageb
    ds_read_b128 v[68:71], v231 offset:0
    ds_read_b128 v[72:75], v231 offset:2176
    ds_read_b128 v[76:79], v231 offset:256
    ds_read_b128 v[80:83], v231 offset:2432
    ds_read_b32 v252, v232
    s_cmp_eq_u32 s101, 1
    s_waitcnt lgkmcnt(3)
    v_pk_add_f32 v[68:69], v[68:69], v[72:73]
    v_pk_add_f32 v[70:71], v[70:71], v[74:75]
    s_waitcnt lgkmcnt(1)
    v_pk_add_f32 v[76:77], v[76:77], v[80:81]
    v_pk_add_f32 v[78:79], v[78:79], v[82:83]
    s_waitcnt lgkmcnt(0)
    v_add_f32_dpp v252, v252, v252 quad_perm:[1,0,3,2] row_mask:0xf bank_mask:0xf
    v_permlane32_swap_b32 v68, v76
    v_permlane32_swap_b32 v69, v77
    v_permlane32_swap_b32 v70, v78
    v_permlane32_swap_b32 v71, v79
    v_add_f32_dpp v252, v252, v252 quad_perm:[2,3,0,1] row_mask:0xf bank_mask:0xf
    v_pk_add_f32 v[68:69], v[68:69], v[76:77]
    v_pk_add_f32 v[70:71], v[70:71], v[78:79]
    v_add_f32_dpp v252, v252, v252 row_half_mirror row_mask:0xf bank_mask:0xf
    s_nop 0
    v_permlane16_swap_b32 v68, v70
    v_permlane16_swap_b32 v69, v71
    v_pk_add_f32 v[64:65], v[68:69], v[70:71]
    v_bfi_b32 v252, s70, v4, v252
    v_bfi_b32 v64, s70, v4, v64
    v_bfi_b32 v65, s70, v4, v65
    s_cbranch_scc1 L_olocal
    buffer_store_dwordx2 v[64:65], v233, s[52:55], s26 offen sc1
    s_mov_b64 exec, 1
    buffer_store_dwordx3 v[250:252], off, s[52:55], s60 offset:2048 sc1
    s_branch L_ostored
L_olocal:
    buffer_store_dwordx2 v[64:65], v233, s[52:55], s26 offen
    s_mov_b64 exec, 1
    buffer_store_dwordx3 v[250:252], off, s[52:55], s60 offset:2048
L_ostored:
    s_mov_b64 exec, -1
    s_mov_b32 s13, 262144
L_opoll:
    buffer_load_dwordx3 v[84:86], v237, s[52:55], s69 offen offset:2048 sc1
    buffer_load_dwordx4 v[68:71], v236, s[52:55], s69 offen offset:0 sc1
    buffer_load_dwordx4 v[72:75], v236, s[52:55], s69 offen offset:128 sc1
    buffer_load_dwordx4 v[76:79], v236, s[52:55], s69 offen offset:256 sc1
    buffer_load_dwordx4 v[80:83], v236, s[52:55], s69 offen offset:384 sc1
    s_mov_b64 s[10:11], exec
    s_sub_u32 s13, s13, 1
    s_waitcnt vmcnt(4)
    v_xor_b32 v85, v85, v4
    v_xor_b32 v84, v84, v4
    v_xor_b32 v86, v86, v4
    s_mov_b64 exec, -1
    v_max_f32_dpp v64, v85, v85 row_ror:8 row_mask:0xf bank_mask:0xf
    v_mov_b32 v65, v64
    v_lshrrev_b32 v66, 12, v84
    v_or3_b32 v87, v84, v85, v86
    v_permlane16_swap_b32 v64, v65
    v_max_f32 v64, v64, v65
    v_mov_b32 v65, v64
    v_bfi_b32 v66, s70, v66, v85
    s_nop 0
    v_permlane32_swap_b32 v64, v65
    v_max_f32 v64, v64, v65
    v_sub_f32 v64, v66, v64
    v_exp_f32 v64, v64
    s_mov_b64 exec, s[10:11]
    s_waitcnt vmcnt(3)
    v_xor_b32 v68, v68, v4
    v_xor_b32 v69, v69, v4
    v_xor_b32 v70, v70, v4
    v_xor_b32 v71, v71, v4
    v_or3_b32 v87, v68, v69, v87
    v_or3_b32 v87, v70, v71, v87
    s_waitcnt vmcnt(2)
    v_xor_b32 v72, v72, v4
    v_xor_b32 v73, v73, v4
    v_xor_b32 v74, v74, v4
    v_xor_b32 v75, v75, v4
    v_or3_b32 v87, v72, v73, v87
    v_or3_b32 v87, v74, v75, v87
    s_waitcnt vmcnt(1)
    v_xor_b32 v76, v76, v4
    v_xor_b32 v77, v77, v4
    v_xor_b32 v78, v78, v4
    v_xor_b32 v79, v79, v4
    v_or3_b32 v87, v76, v77, v87
    v_or3_b32 v87, v78, v79, v87
    s_waitcnt vmcnt(0)
    v_xor_b32 v80, v80, v4
    v_xor_b32 v81, v81, v4
    v_xor_b32 v82, v82, v4
    v_xor_b32 v83, v83, v4
    v_or3_b32 v87, v80, v81, v87
    v_or3_b32 v87, v82, v83, v87
    v_and_b32 v87, s70, v87
    s_cbranch_scc1 L_odone
    v_cmpx_ne_u32 vcc, 0, v87
    s_cbranch_execnz L_opoll
L_odone:
    s_mov_b64 exec, -1
    v_mul_f32 v86, v86, v64
    v_pk_mul_f32 v[68:69], v[68:69], v[64:65] op_sel_hi:[1,0]
    v_pk_mul_f32 v[76:77], v[76:77], v[64:65] op_sel_hi:[1,0]
    v_pk_mul_f32 v[72:73], v[72:73], v[64:65] op_sel_hi:[1,0]
    v_pk_mul_f32 v[80:81], v[80:81], v[64:65] op_sel_hi:[1,0]
    v_pk_mul_f32 v[70:71], v[70:71], v[64:65] op_sel_hi:[1,0]
    v_pk_mul_f32 v[78:79], v[78:79], v[64:65] op_sel_hi:[1,0]
    v_pk_mul_f32 v[74:75], v[74:75], v[64:65] op_sel_hi:[1,0]
    v_pk_mul_f32 v[82:83], v[82:83], v[64:65] op_sel_hi:[1,0]
    v_mov_b32 v65, v86
    v_permlane32_swap_b32 v68, v76
    v_permlane32_swap_b32 v69, v77
    v_permlane32_swap_b32 v70, v78
    v_permlane32_swap_b32 v71, v79
    v_permlane32_swap_b32 v72, v80
    v_permlane32_swap_b32 v73, v81
    v_permlane32_swap_b32 v74, v82
    v_permlane32_swap_b32 v75, v83
    v_permlane32_swap_b32 v86, v65
    v_pk_add_f32 v[68:69], v[68:69], v[76:77]
    v_pk_add_f32 v[72:73], v[72:73], v[80:81]
    v_pk_add_f32 v[70:71], v[70:71], v[78:79]
    v_pk_add_f32 v[74:75], v[74:75], v[82:83]
    v_add_f32 v86, v86, v65
    v_mov_b32 v65, v86
    v_permlane16_swap_b32 v68, v72
    v_permlane16_swap_b32 v69, v73
    v_permlane16_swap_b32 v70, v74
    v_permlane16_swap_b32 v71, v75
    v_permlane16_swap_b32 v86, v65
    v_add_f32 v86, v86, v65
    v_pk_add_f32 v[68:69], v[68:69], v[72:73]
    v_pk_add_f32 v[70:71], v[70:71], v[74:75]
    v_add_f32_dpp v86, v86, v86 row_ror:8 row_mask:0xf bank_mask:0xf
    s_nop 0
    v_add_f32_dpp v68, v68, v68 row_ror:8 row_mask:0xf bank_mask:0xf
    v_add_f32_dpp v69, v69, v69 row_ror:8 row_mask:0xf bank_mask:0xf
    v_add_f32_dpp v70, v70, v70 row_ror:8 row_mask:0xf bank_mask:0xf
    v_add_f32_dpp v71, v71, v71 row_ror:8 row_mask:0xf bank_mask:0xf
    v_rcp_f32 v64, v86
    s_cmp_lt_u32 s3, 1
    v_pk_mul_f32 v[68:69], v[68:69], v[64:65] op_sel_hi:[1,0]
    v_pk_mul_f32 v[70:71], v[70:71], v[64:65] op_sel_hi:[1,0]
    v_cvt_pk_bf16_f32 v68, v68, v69
    v_cvt_pk_bf16_f32 v69, v70, v71
    ds_write_b64 v238, v[68:69] offset:1600
    s_mov_b32 s13, 262144
    s_waitcnt lgkmcnt(0)
    s_barrier
    s_cbranch_scc0 L_fin
    buffer_load_dwordx4 v[64:67], v244, s[52:55], s61 offen sc1
L_ppoll:
    buffer_load_dwordx4 v[72:75], v244, s[52:55], s61 offen sc1
    s_waitcnt vmcnt(1)
    v_xor_b32 v64, v64, v4
    v_xor_b32 v65, v65, v4
    v_xor_b32 v66, v66, v4
    v_xor_b32 v67, v67, v4
    v_or3_b32 v68, v64, v65, v66
    v_or_b32 v68, v67, v68
    v_and_b32 v68, s70, v68
    v_cmpx_ne_u32 vcc, 0, v68
    s_cbranch_execz L_pdone
    buffer_load_dwordx4 v[76:79], v244, s[52:55], s61 offen sc1
    s_waitcnt vmcnt(1)
    v_mov_b64 v[64:65], v[72:73]
    v_mov_b64 v[66:67], v[74:75]
    v_xor_b32 v64, v64, v4
    v_xor_b32 v65, v65, v4
    v_xor_b32 v66, v66, v4
    v_xor_b32 v67, v67, v4
    v_or3_b32 v68, v64, v65, v66
    v_or_b32 v68, v67, v68
    v_and_b32 v68, s70, v68
    v_cmpx_ne_u32 vcc, 0, v68
    s_cbranch_execz L_pdone
    s_sub_u32 s13, s13, 1
    s_cbranch_scc1 L_pdone
    buffer_load_dwordx4 v[72:75], v244, s[52:55], s61 offen sc1
    s_waitcnt vmcnt(1)
    v_mov_b64 v[64:65], v[76:77]
    v_mov_b64 v[66:67], v[78:79]
    v_xor_b32 v64, v64, v4
    v_xor_b32 v65, v65, v4
    v_xor_b32 v66, v66, v4
    v_xor_b32 v67, v67, v4
    v_or3_b32 v68, v64, v65, v66
    v_or_b32 v68, v67, v68
    v_and_b32 v68, s70, v68
    v_cmpx_ne_u32 vcc, 0, v68
    s_cbranch_execz L_pdone
L_pp3:
    buffer_load_dwordx4 v[76:79], v244, s[52:55], s61 offen sc1
    s_waitcnt vmcnt(1)
    v_mov_b64 v[64:65], v[72:73]
    v_mov_b64 v[66:67], v[74:75]
    v_xor_b32 v64, v64, v4
    v_xor_b32 v65, v65, v4
    v_xor_b32 v66, v66, v4
    v_xor_b32 v67, v67, v4
    v_or3_b32 v68, v64, v65, v66
    v_or_b32 v68, v67, v68
    v_and_b32 v68, s70, v68
    v_cmpx_ne_u32 vcc, 0, v68
    s_cbranch_execz L_pdone
    s_sub_u32 s13, s13, 1
    s_cbranch_scc1 L_pdone
    buffer_load_dwordx4 v[72:75], v244, s[52:55], s61 offen sc1
    s_waitcnt vmcnt(1)
    v_mov_b64 v[64:65], v[76:77]
    v_mov_b64 v[66:67], v[78:79]
    v_xor_b32 v64, v64, v4
    v_xor_b32 v65, v65, v4
    v_xor_b32 v66, v66, v4
    v_xor_b32 v67, v67, v4
    v_or3_b32 v68, v64, v65, v66
    v_or_b32 v68, v67, v68
    v_and_b32 v68, s70, v68
    v_cmpx_ne_u32 vcc, 0, v68
    s_cbranch_execnz L_pp3
L_pdone:
    s_mov_b64 exec, -1
    s_nop 1
    v_permlane32_swap_b32 v64, v66
    v_permlane32_swap_b32 v65, v67
    v_add_f32 v64, v64, v66
    v_add_f32 v65, v65, v67
    s_nop 1
    v_permlane16_swap_b32 v64, v65
    v_add_f32 v64, v64, v65
    s_nop 1
    v_add_f32_dpp v64, v64, v64 row_ror:8 row_mask:0xf bank_mask:0xf
    s_nop 1
    v_add_f32_dpp v64, v64, v64 row_ror:4 row_mask:0xf bank_mask:0xf
    s_nop 1
    v_add_f32_dpp v64, v64, v64 quad_perm:[2,3,0,1] row_mask:0xf bank_mask:0xf
    v_add_f32 v64, v64, v227
    v_cvt_pk_bf16_f32 v64, v64, v64
    s_mov_b32 exec_lo, 0x00030003
    s_mov_b32 exec_hi, 0x00030003
    global_store_short v226, v64, s[38:39]
    s_cmp_eq_u32 s2, 0
    s_cbranch_scc0 L_fin
    s_mov_b64 exec, 1
    v_mov_b32 v65, s62
    buffer_store_dword v65, off, s[52:55], 0 sc1
    s_branch L_fin
L_stageb:
    ds_read_b128 v[52:55], v240 offset:1024
    ds_read_b128 v[56:59], v240 offset:1088
    ds_read_b64 v[92:93], v245 offset:1536
    s_waitcnt vmcnt(0) lgkmcnt(0)
    s_barrier
    ds_read_b128 v[64:67], v239 offset:1600
    ds_read_b64_tr_b16 v[28:29], v241 offset:20096
    ds_read_b64_tr_b16 v[30:31], v241 offset:20224
    ds_read_b128 v[68:71], v239 offset:1664
    ds_read_b64_tr_b16 v[32:33], v241 offset:24192
    ds_read_b64_tr_b16 v[34:35], v241 offset:24320
    ds_read_b64_tr_b16 v[44:45], v242 offset:36480
    ds_read_b64_tr_b16 v[46:47], v242 offset:36992
    ds_read_b128 v[72:75], v239 offset:1728
    ds_read_b64_tr_b16 v[36:37], v241 offset:28288
    ds_read_b64_tr_b16 v[38:39], v241 offset:28416
    ds_read_b128 v[76:79], v239 offset:1792
    ds_read_b64_tr_b16 v[40:41], v241 offset:32384
    ds_read_b64_tr_b16 v[42:43], v241 offset:32512
    s_waitcnt lgkmcnt(11)
    v_mfma_f32_16x16x32_bf16 v[80:83], v[28:31], v[64:67], 0
    ds_read_b64_tr_b16 v[48:49], v242 offset:40576
    ds_read_b64_tr_b16 v[50:51], v242 offset:41088
    s_waitcnt lgkmcnt(10)
    v_mfma_f32_16x16x32_bf16 v[80:83], v[32:35], v[68:71], v[80:83]
    s_waitcnt lgkmcnt(8)
    v_mfma_f32_16x16x32_bf16 v[88:91], v[44:47], v[52:55], 0
    s_waitcnt lgkmcnt(5)
    v_mfma_f32_16x16x32_bf16 v[80:83], v[36:39], v[72:75], v[80:83]
    s_waitcnt lgkmcnt(2)
    v_mfma_f32_16x16x32_bf16 v[80:83], v[40:43], v[76:79], v[80:83]
    s_waitcnt lgkmcnt(0)
    v_mfma_f32_16x16x32_bf16 v[88:91], v[48:51], v[56:59], v[88:91]
    s_mov_b64 exec, s[64:65]
    s_nop 4
    v_mul_f32 v80, v80, v92
    v_mul_f32 v81, v81, v92
    v_mul_f32 v82, v82, v92
    v_mul_f32 v83, v83, v92
    v_fmac_f32 v80, v88, v93
    v_fmac_f32 v81, v89, v93
    v_fmac_f32 v82, v90, v93
    v_fmac_f32 v83, v91, v93
    v_add_u32 v80, 0x800, v80
    v_add_u32 v81, 0x800, v81
    v_add_u32 v82, 0x800, v82
    v_add_u32 v83, 0x800, v83
    v_bfi_b32 v80, s70, v4, v80
    v_bfi_b32 v81, s70, v4, v81
    v_bfi_b32 v82, s70, v4, v82
    v_bfi_b32 v83, s70, v4, v83
    buffer_store_dwordx4 v[80:83], v243, s[52:55], s27 offen sc1
L_fin:
L_end:
    s_endpgm
    .fill 256, 4, 0xbf800000
.section .rodata,"a"

.p2align 6
.amdhsa_kernel gated_mix__gqa_block_cached__dense_activation_gelu__decode_kernel
  .amdhsa_next_free_vgpr 256
  .amdhsa_next_free_sgpr 102
  .amdhsa_accum_offset 256
  .amdhsa_group_segment_fixed_size 0
  .amdhsa_kernarg_size 112
  .amdhsa_user_sgpr_count 2
  .amdhsa_user_sgpr_kernarg_segment_ptr 1
  .amdhsa_system_sgpr_workgroup_id_x 1
.end_amdhsa_kernel
```
